```python
import torch

def _softmax(x, axis=-1):
    return torch.softmax(x, dim=axis)
def _gelu(x):
    return torch.nn.functional.gelu(x, approximate="tanh")
def _silu(x):
    return torch.nn.functional.silu(x)
def _sigmoid(x):
    return torch.sigmoid(x)
def _layernorm(x, axis=-1, eps=1e-5):
    m = x.mean(dim=axis, keepdim=True)
    v = x.var(dim=axis, keepdim=True, unbiased=False)
    return (x - m) / torch.sqrt(v + eps)
def _scatter_add(tgt, idx, src, axis=0):
    return tgt.clone().index_add_(axis, idx, src)
def _segment_sum(src, seg, n):
    out = torch.zeros((n,) + src.shape[1:], dtype=src.dtype)
    return out.index_add_(0, seg, src)
def _pad(x, pw):
    flat = tuple(v for pair in reversed(pw) for v in pair)
    return torch.nn.functional.pad(x, flat)

kernel_name = 'concat_heads__spectral_gfnet__linear_attn_block__prompt'

def setup_inputs():

    _w = (lambda a: (lambda t: t.to(torch.bfloat16) if t.is_floating_point() else t)(torch.as_tensor(a)))
    def _A_setup():
        B, S, D = 1, 2048, 512
        Df = D // 2 + 1
        return {
            "x": _w((lambda *s: torch.randn(*s, dtype=torch.bfloat16) * 0.05)(B, S, D)),
            "w_r": _w((lambda *s: torch.randn(*s, dtype=torch.bfloat16) * 1.6)(S, Df) * 0.02),
            "w_i": _w((lambda *s: torch.randn(*s, dtype=torch.bfloat16) * 1.6)(S, Df) * 0.02),
        }
    _A_in = _A_setup()

    def _B_setup():
        B, S, D = 1, 2048, 512
        return {
            "x": _w((lambda *s: torch.randn(*s, dtype=torch.bfloat16) * 0.05)(B, S, D)),
            "wqkv": _w((lambda *s: torch.randn(*s, dtype=torch.bfloat16) * 0.4)(D, 3 * D)),
            "wo": _w((lambda *s: torch.randn(*s, dtype=torch.bfloat16) * 0.05)(D, D)),
        }
    _B_in = _B_setup()

    return {
        "A_x": _A_in["x"],
        "A_w_r": _A_in["w_r"],
        "A_w_i": _A_in["w_i"],
        "B_x": _B_in["x"],
        "B_wqkv": _B_in["wqkv"],
        "B_wo": _B_in["wo"],
    }

def reference(A_x, A_w_r, A_w_i, B_x, B_wqkv, B_wo):
    def _A_ref(x, w_r, w_i):
        B, S, D = x.shape
        X = (lambda x, axes=(-2,-1): torch.fft.rfft2(x.float(), dim=axes))(x, axes=(-2, -1))
        W = w_r + 1j * w_i
        X = X * W
        y = (lambda x, s, axes=(-2,-1): torch.fft.irfft2(x, s=s, dim=axes).to(torch.bfloat16))(X, (S, D), axes=(-2, -1))
        return y

    def _B_ref(x, wqkv, wo):
        B, S, D = x.shape
        H = 32; Dh = D // H
        qkv = (lambda x, *d: x.permute(*d))((x @ wqkv).reshape(B, S, 3, H, Dh), 2, 0, 3, 1, 4)
        q, k, v = qkv[0], qkv[1], qkv[2]
        phi = lambda t: torch.where(t > 0, t + 1, torch.exp(t)) + 1e-6
        pq, pk = phi(q), phi(k)
        kv = torch.einsum("bhsd,bhse->bhde", pk, v)
        z = torch.einsum("bhsd->bhd", pk)
        num = torch.einsum("bhqd,bhde->bhqe", pq, kv)
        den = torch.einsum("bhqd,bhd->bhq", pq, z)[..., None] + 1e-6
        o = num / den
        return (lambda x, *d: x.permute(*d))(o, 0, 2, 1, 3).reshape(B, S, D) @ wo

    a = _A_ref(A_x, A_w_r, A_w_i)
    b = _B_ref(B_x, B_wqkv, B_wo)
    return torch.concatenate([a, b], axis=-1)
```

```asm
; @launch grid=(256,1,1) block=(512,1,1) lds=163840
.amdgcn_target "amdgcn-amd-amdhsa--gfx950"
.text
.globl concat_heads__spectral_gfnet__linear_attn_block__prompt_kernel
.p2align 8
.type concat_heads__spectral_gfnet__linear_attn_block__prompt_kernel,@function
concat_heads__spectral_gfnet__linear_attn_block__prompt_kernel:
    s_cmp_ge_u32 s2, 256
    s_cbranch_scc1 L_end
    s_load_dwordx16 s[4:19], s[0:1], 0
    s_load_dwordx2 s[20:21], s[0:1], 64
    s_bitcmp1_b32 s2, 3
    s_cbranch_scc1 L_nopf
    s_getpc_b64 s[44:45]
L_pc:
    v_lshlrev_b32 v2, 7, v0
    v_cmp_gt_u32 vcc, L_code_end-L_pc-4, v2
    v_mov_b32 v3, s45
    s_and_saveexec_b64 s[46:47], vcc
    s_cbranch_execz L_nopf
    v_add_co_u32 v2, vcc, s44, v2
    s_nop 1
    v_addc_co_u32 v3, vcc, 0, v3, vcc
    global_load_dword v254, v[2:3], off
L_nopf:
    s_mov_b64 exec, -1
    v_lshrrev_b32 v1, 6, v0
    v_and_b32 v0, 63, v0
    v_readfirstlane_b32 s3, v1
    v_lshlrev_b32 v6, 4, v0
    v_lshrrev_b32 v2, 4, v0
    v_and_b32 v3, 3, v0
    v_lshrrev_b32 v4, 3, v0
    v_bfe_u32 v5, v0, 2, 1
    v_and_b32 v1, 15, v0
    s_bitcmp1_b32 s2, 3
    s_cbranch_scc0 L_A
    s_and_b32 s44, s2, 7
    s_lshr_b32 s45, s2, 7
    s_lshl_b32 s56, s44, 1
    s_add_u32 s56, s56, s45
    s_bfe_u32 s57, s2, 0x30004
    s_lshl_b32 s45, s45, 2
    s_add_u32 s58, s57, s44
    s_add_u32 s58, s58, s45
    s_cmp_lt_u32 s3, 4
    s_cbranch_scc1 B_compute
    s_setprio 1
    s_sub_u32 s59, s3, 4
    v_and_b32 v12, 7, v0
    v_xor_b32 v13, v12, v2
    v_lshlrev_b32 v13, 4, v13
    v_lshl_add_u32 v40, v4, 10, v13
    v_xor_b32 v13, 64, v40
    v_add_u32 v41, 7168, v13
    v_add_u32 v42, 14336, v40
    v_add_u32 v43, 21504, v13
    s_lshl_b32 s44, s56, 2
    s_add_u32 s44, s44, s59
    s_lshl_b32 s44, s44, 15
    s_and_b32 s55, s58, 7
    s_lshl_b32 s62, s55, 7
    s_add_u32 s62, s62, s44
    s_lshl_b32 s54, s59, 12
    s_mov_b32 m0, s54
    s_mov_b32 s26, 0x200000
    s_mov_b32 s27, 0x20000
    s_waitcnt lgkmcnt(0)
    s_mov_b32 s24, s10
    s_mov_b32 s25, s11
    buffer_load_dwordx4 v40, s[24:27], s62 offen offset:0  lds
    buffer_load_dwordx4 v41, s[24:27], s62 offen offset:1024  lds
    buffer_load_dwordx4 v42, s[24:27], s62 offen offset:2048  lds
    buffer_load_dwordx4 v43, s[24:27], s62 offen offset:3072  lds
    s_mul_i32 s45, s59, 49152
    s_lshl_b32 s46, s57, 7
    s_add_u32 s45, s45, s46
    v_bfe_u32 v12, v0, 2, 2
    v_xor_b32 v12, v12, v2
    v_lshrrev_b32 v13, 1, v12
    v_and_b32 v12, 1, v12
    v_lshlrev_b32 v12, 6, v12
    v_lshl_add_u32 v12, v13, 10, v12
    v_lshl_add_u32 v12, v3, 4, v12
    v_mul_u32_u24 v13, 3072, v2
    v_add_u32 v12, v12, v13
    v_add_u32 v44, 1024, v12
    v_add_u32 v45, 12288, v12
    v_add_u32 v46, 23552, v12
    v_add_u32 v47, 34816, v12
    s_mov_b32 s28, s12
    s_mov_b32 s29, s13
    s_mov_b32 s30, 0x180000
    s_mov_b32 s31, 0x20000
    s_mov_b32 s87, 0
    s_mul_i32 s63, s55, 196608
    s_load_dword s22, s[20:21], 256
    s_add_u32 m0, m0, 16384
    s_add_u32 s63, s63, s45
    buffer_load_dwordx4 v44, s[28:31], s63 offen offset:0  lds
    buffer_load_dwordx4 v45, s[28:31], s63 offen offset:1024  lds
    buffer_load_dwordx4 v46, s[28:31], s63 offen offset:2048  lds
    buffer_load_dwordx4 v47, s[28:31], s63 offen offset:3072  lds
    s_add_u32 s55, s55, 1
    s_add_u32 s54, s54, 0x8000
    s_and_b32 s54, s54, 0x1ffff
    s_and_b32 s55, s55, 7
    s_lshl_b32 s62, s55, 7
    s_add_u32 s62, s62, s44
    s_mov_b32 m0, s54
    s_mul_i32 s63, s55, 196608
    buffer_load_dwordx4 v40, s[24:27], s62 offen offset:0  lds
    buffer_load_dwordx4 v41, s[24:27], s62 offen offset:1024  lds
    buffer_load_dwordx4 v42, s[24:27], s62 offen offset:2048  lds
    buffer_load_dwordx4 v43, s[24:27], s62 offen offset:3072  lds
    s_add_u32 m0, m0, 16384
    s_add_u32 s63, s63, s45
    buffer_load_dwordx4 v44, s[28:31], s63 offen offset:0  lds
    buffer_load_dwordx4 v45, s[28:31], s63 offen offset:1024  lds
    buffer_load_dwordx4 v46, s[28:31], s63 offen offset:2048  lds
    buffer_load_dwordx4 v47, s[28:31], s63 offen offset:3072  lds
    s_add_u32 s55, s55, 1
    s_add_u32 s54, s54, 0x8000
    s_and_b32 s54, s54, 0x1ffff
    s_mov_b32 s32, s14
    s_mov_b32 s33, s15
    s_mov_b32 s34, 0x80000
    s_mov_b32 s35, 0x20000
    s_mov_b32 s40, s20
    s_mov_b32 s41, s21
    s_mov_b32 s42, 0x700000
    s_mov_b32 s43, 0x20000
    v_and_b32 v12, 1, v2
    v_xor_b32 v12, v12, v5
    v_lshlrev_b32 v12, 6, v12
    v_lshl_add_u32 v14, v3, 4, v12
    v_mul_u32_u24 v13, 3072, v4
    v_add_u32 v48, v14, v13
    v_add_u32 v49, 23552, v48
    s_lshl_b32 s80, s59, 11
    v_lshl_add_u32 v100, v4, 10, v14
    v_add_u32 v101, 7168, v100
    v_add_u32 v102, 14336, v100
    v_add_u32 v103, 21504, v100
    s_and_b32 s49, s59, 1
    s_lshr_b32 s50, s59, 1
    s_lshl_b32 s51, s57, 4
    s_add_u32 s51, s51, s56
    s_lshl_b32 s51, s51, 1
    s_add_u32 s51, s51, s49
    s_lshl_b32 s51, s51, 10
    s_add_u32 s81, s51, 6553600
    s_lshl_b32 s51, s49, 12
    s_add_u32 s51, s51, 131072
    v_add_u32 v116, s51, v6
    s_movk_i32 s52, 1024
    s_movk_i32 s53, 2048
    s_mov_b64 s[0:1], -1
    s_cmp_eq_u32 s50, 0
    s_cbranch_scc1 B_pubsel
    s_lshl_b32 s51, s57, 1
    s_add_u32 s51, s51, s49
    s_lshl_b32 s51, s51, 4
    s_add_u32 s51, s51, s56
    s_lshl_b32 s51, s51, 6
    s_add_u32 s81, s51, 6815744
    s_lshl_b32 s51, s49, 8
    s_add_u32 s51, s51, 139264
    v_and_b32 v12, 1, v3
    v_lshrrev_b32 v13, 1, v3
    v_lshlrev_b32 v12, 4, v12
    v_lshl_add_u32 v12, v13, 6, v12
    v_add_u32 v116, s51, v12
    s_movk_i32 s52, 32
    s_movk_i32 s53, 128
    s_mov_b64 s[0:1], 15
B_pubsel:
    v_add_u32 v117, s52, v116
    v_add_u32 v118, s53, v116
    v_add_u32 v119, s53, v117
    s_lshl_b32 s51, s57, 15
    s_lshl_b32 s52, s50, 9
    s_lshl_b32 s53, s49, 10
    s_add_u32 s52, s52, s53
    s_add_u32 s51, s51, s52
    s_add_u32 s82, s51, 6553600
    s_add_u32 s52, s52, 140288
    v_and_b32 v12, 31, v0
    v_lshrrev_b32 v13, 5, v0
    v_lshlrev_b32 v12, 4, v12
    v_lshl_add_u32 v114, v13, 11, v12
    v_lshl_add_u32 v12, v13, 3, v12
    v_add_u32 v112, s52, v12
    s_lshl_b32 s51, s57, 11
    s_add_u32 s51, s51, s53
    s_add_u32 s83, s51, 6815744
    s_lshl_b32 s51, s49, 6
    s_add_u32 s51, s51, 142336
    v_and_b32 v12, 1, v2
    v_lshlrev_b32 v12, 2, v12
    v_lshl_add_u32 v12, v13, 3, v12
    v_lshl_add_u32 v12, v3, 4, v12
    v_add_u32 v113, s51, v12
    s_mov_b32 s84, 0x3f80
    s_mov_b32 s85, 0x3f800000
    v_and_b32 v12, 31, v0
    v_and_b32 v13, 1, v0
    v_lshlrev_b32 v13, 4, v13
    v_mov_b32 v14, 0x3f80
    v_lshlrev_b32 v13, v13, v14
    v_lshrrev_b32 v12, 1, v12
    v_cmp_eq_u32 vcc, 0, v12
    s_nop 1
    v_cndmask_b32 v172, 0, v13, vcc
    v_cmp_eq_u32 vcc, 1, v12
    s_nop 1
    v_cndmask_b32 v173, 0, v13, vcc
    v_cmp_eq_u32 vcc, 2, v12
    s_nop 1
    v_cndmask_b32 v174, 0, v13, vcc
    v_cmp_eq_u32 vcc, 3, v12
    s_nop 1
    v_cndmask_b32 v175, 0, v13, vcc
    s_getreg_b32 s18, hwreg(HW_REG_XCC_ID, 0, 4)
    s_lshl_b32 s18, s18, 1
    s_lshl_b32 s19, s56, 9
    s_add_u32 s19, s19, 6881280
    s_setprio 0
    s_branch B_ld1
B_ld0:
    s_and_b32 s55, s55, 7
    s_lshl_b32 s62, s55, 7
    s_add_u32 s62, s62, s44
    s_mov_b32 m0, s54
    s_mul_i32 s63, s55, 196608
    buffer_load_dwordx4 v40, s[24:27], s62 offen offset:0  lds
    buffer_load_dwordx4 v41, s[24:27], s62 offen offset:1024  lds
    buffer_load_dwordx4 v42, s[24:27], s62 offen offset:2048  lds
    buffer_load_dwordx4 v43, s[24:27], s62 offen offset:3072  lds
    s_add_u32 m0, m0, 16384
    s_add_u32 s63, s63, s45
    buffer_load_dwordx4 v44, s[28:31], s63 offen offset:0  lds
    buffer_load_dwordx4 v45, s[28:31], s63 offen offset:1024  lds
    buffer_load_dwordx4 v46, s[28:31], s63 offen offset:2048  lds
    buffer_load_dwordx4 v47, s[28:31], s63 offen offset:3072  lds
    s_add_u32 s55, s55, 1
    s_add_u32 s54, s54, 0x8000
    s_and_b32 s54, s54, 0x1ffff
B_ld1:
    s_waitcnt vmcnt(8)
    s_barrier
    s_add_u32 s87, s87, 1
    s_cmp_lt_u32 s87, 7
    s_cbranch_scc1 B_ld0
    s_and_b32 s55, s55, 7
    s_mul_i32 s63, s55, 196608
    s_add_u32 m0, s80, 0
    s_add_u32 s63, s63, s45
    s_add_u32 s55, s55, 1
    buffer_load_dwordx4 v48, s[28:31], s63 offen offset:0  lds
    buffer_load_dwordx4 v49, s[28:31], s63 offen offset:1024  lds
    s_and_b32 s55, s55, 7
    s_mul_i32 s63, s55, 196608
    s_add_u32 m0, s80, 8192
    s_add_u32 s63, s63, s45
    s_add_u32 s55, s55, 1
    buffer_load_dwordx4 v48, s[28:31], s63 offen offset:0  lds
    buffer_load_dwordx4 v49, s[28:31], s63 offen offset:1024  lds
    s_and_b32 s55, s55, 7
    s_mul_i32 s63, s55, 196608
    s_add_u32 m0, s80, 16384
    s_add_u32 s63, s63, s45
    s_add_u32 s55, s55, 1
    buffer_load_dwordx4 v48, s[28:31], s63 offen offset:0  lds
    buffer_load_dwordx4 v49, s[28:31], s63 offen offset:1024  lds
    s_and_b32 s55, s55, 7
    s_mul_i32 s63, s55, 196608
    s_add_u32 m0, s80, 24576
    s_add_u32 s63, s63, s45
    s_add_u32 s55, s55, 1
    buffer_load_dwordx4 v48, s[28:31], s63 offen offset:0  lds
    buffer_load_dwordx4 v49, s[28:31], s63 offen offset:1024  lds
    v_lshlrev_b32 v12, 3, v3
    s_waitcnt lgkmcnt(0)
    s_add_u32 s22, s22, 1
    s_mul_i32 s60, s22, 0x01010101
    s_xor_b32 s60, s60, 0xcccccccc
    v_lshrrev_b32 v13, v12, s60
    s_mov_b32 s60, 0x10001
    v_bfe_u32 v8, v13, 0, 2
    v_bfe_u32 v9, v13, 2, 2
    v_bfe_u32 v10, v13, 4, 2
    v_bfe_u32 v11, v13, 6, 2
    v_lshl_or_b32 v8, v8, 15, v8
    v_lshl_or_b32 v9, v9, 15, v9
    v_lshl_or_b32 v10, v10, 15, v10
    v_lshl_or_b32 v11, v11, 15, v11
    v_and_b32 v8, s60, v8
    v_and_b32 v9, s60, v9
    v_and_b32 v10, s60, v10
    v_and_b32 v11, s60, v11
    s_lshl_b32 s62, s57, 6
    s_add_u32 s62, s62, s19
    v_mov_b32 v104, s18
    v_mov_b32 v105, s18
    v_mov_b32 v106, s18
    v_mov_b32 v107, s18
    v_bfi_b32 v104, s60, v8, v104
    v_bitop3_b32 v105, s60, v9, v105 bitop3:0x3a
    v_bfi_b32 v106, s60, v10, v106
    v_bitop3_b32 v107, s60, v11, v107 bitop3:0x3a
    v_and_b32 v115, 0x1ff, v6
    s_mov_b64 exec, 15
    buffer_store_dwordx4 v[104:107], v6, s[40:43], s62 offen sc1
    s_mov_b64 exec, -1
    s_waitcnt vmcnt(9)
    s_barrier
    s_and_b32 s55, s55, 7
    s_mul_i32 s63, s55, 196608
    s_add_u32 m0, s80, 32768
    s_add_u32 s63, s63, s45
    s_add_u32 s55, s55, 1
    buffer_load_dwordx4 v48, s[28:31], s63 offen offset:0  lds
    buffer_load_dwordx4 v49, s[28:31], s63 offen offset:1024  lds
    s_and_b32 s55, s55, 7
    s_mul_i32 s63, s55, 196608
    s_add_u32 m0, s80, 40960
    s_add_u32 s63, s63, s45
    s_add_u32 s55, s55, 1
    buffer_load_dwordx4 v48, s[28:31], s63 offen offset:0  lds
    buffer_load_dwordx4 v49, s[28:31], s63 offen offset:1024  lds
    s_and_b32 s55, s55, 7
    s_mul_i32 s63, s55, 196608
    s_add_u32 m0, s80, 49152
    s_add_u32 s63, s63, s45
    s_add_u32 s55, s55, 1
    buffer_load_dwordx4 v48, s[28:31], s63 offen offset:0  lds
    buffer_load_dwordx4 v49, s[28:31], s63 offen offset:1024  lds
    s_and_b32 s55, s55, 7
    s_mul_i32 s63, s55, 196608
    s_add_u32 m0, s80, 57344
    s_add_u32 s63, s63, s45
    s_add_u32 s55, s55, 1
    buffer_load_dwordx4 v48, s[28:31], s63 offen offset:0  lds
    buffer_load_dwordx4 v49, s[28:31], s63 offen offset:1024  lds
    s_waitcnt vmcnt(0)
    s_barrier
    s_setprio 1
    ds_read_b128 v[156:159], v116
    ds_read_b128 v[164:167], v118
    ds_read_b128 v[160:163], v117
    ds_read_b128 v[168:171], v119
    s_waitcnt lgkmcnt(2)
    v_add_f32 v156, v156, v164
    v_add_f32 v157, v157, v165
    v_add_f32 v158, v158, v166
    v_add_f32 v159, v159, v167
    v_cvt_pk_bf16_f32 v120, v156, v157
    v_cvt_pk_bf16_f32 v121, v158, v159
    s_waitcnt lgkmcnt(0)
    v_add_f32 v160, v160, v168
    v_add_f32 v161, v161, v169
    v_add_f32 v162, v162, v170
    v_add_f32 v163, v163, v171
    v_cvt_pk_bf16_f32 v122, v160, v161
    v_cvt_pk_bf16_f32 v123, v162, v163
    v_bfi_b32 v120, s60, v8, v120
    v_bitop3_b32 v121, s60, v9, v121 bitop3:0x3a
    v_bfi_b32 v122, s60, v10, v122
    v_bitop3_b32 v123, s60, v11, v123 bitop3:0x3a
    s_mov_b64 exec, s[0:1]
    buffer_store_dwordx4 v[120:123], v6, s[40:43], s81 offen sc1
    s_mov_b64 exec, -1
    s_mov_b32 s61, 100000
    s_lshl_b32 s62, s59, 16
    s_add_u32 s62, s62, s46
    s_lshl_b32 s63, s59, 13
    s_add_u32 m0, s63, 65536
    s_add_u32 s55, s62, 0
    buffer_load_dwordx4 v100, s[32:35], s55 offen offset:0  lds
    buffer_load_dwordx4 v101, s[32:35], s55 offen offset:1024  lds
    buffer_load_dwordx4 v102, s[32:35], s55 offen offset:2048  lds
    buffer_load_dwordx4 v103, s[32:35], s55 offen offset:3072  lds
    s_add_u32 m0, s63, 69632
    s_add_u32 s55, s62, 32768
    buffer_load_dwordx4 v100, s[32:35], s55 offen offset:0  lds
    buffer_load_dwordx4 v101, s[32:35], s55 offen offset:1024  lds
    buffer_load_dwordx4 v102, s[32:35], s55 offen offset:2048  lds
    buffer_load_dwordx4 v103, s[32:35], s55 offen offset:3072  lds
    s_lshl_b32 s62, s59, 16
    s_add_u32 s62, s62, s46
    s_lshl_b32 s63, s59, 13
    s_add_u32 m0, s63, 98304
    s_add_u32 s55, s62, 262144
    buffer_load_dwordx4 v100, s[32:35], s55 offen offset:0  lds
    buffer_load_dwordx4 v101, s[32:35], s55 offen offset:1024  lds
    buffer_load_dwordx4 v102, s[32:35], s55 offen offset:2048  lds
    buffer_load_dwordx4 v103, s[32:35], s55 offen offset:3072  lds
    s_add_u32 m0, s63, 102400
    s_add_u32 s55, s62, 294912
    buffer_load_dwordx4 v100, s[32:35], s55 offen offset:0  lds
    buffer_load_dwordx4 v101, s[32:35], s55 offen offset:1024  lds
    buffer_load_dwordx4 v102, s[32:35], s55 offen offset:2048  lds
    buffer_load_dwordx4 v103, s[32:35], s55 offen offset:3072  lds
    s_waitcnt vmcnt(16)
B_poll1:
    buffer_load_dwordx4 v[104:107], v115, s[40:43], s19 offen sc1
    buffer_load_dwordx4 v[152:155], v6, s[40:43], s83 offen sc1
    s_mov_b32 s45, s82
    buffer_load_dwordx4 v[120:123], v114, s[40:43], s45 offen sc1
    s_add_u32 s45, s45, 4096
    buffer_load_dwordx4 v[124:127], v114, s[40:43], s45 offen sc1
    s_add_u32 s45, s45, 4096
    buffer_load_dwordx4 v[128:131], v114, s[40:43], s45 offen sc1
    s_add_u32 s45, s45, 4096
    buffer_load_dwordx4 v[132:135], v114, s[40:43], s45 offen sc1
    s_add_u32 s45, s45, 4096
    buffer_load_dwordx4 v[136:139], v114, s[40:43], s45 offen sc1
    s_add_u32 s45, s45, 4096
    buffer_load_dwordx4 v[140:143], v114, s[40:43], s45 offen sc1
    s_add_u32 s45, s45, 4096
    buffer_load_dwordx4 v[144:147], v114, s[40:43], s45 offen sc1
    s_add_u32 s45, s45, 4096
    buffer_load_dwordx4 v[148:151], v114, s[40:43], s45 offen sc1
B_sum:
    s_waitcnt vmcnt(8)
    v_xor_b32 v152, v152, v8
    v_xor_b32 v153, v153, v9
    v_xor_b32 v154, v154, v10
    v_xor_b32 v155, v155, v11
    v_bitop3_b32 v12, v152, v152, v153 bitop3:0xfd
    v_bitop3_b32 v12, v12, v154, v155 bitop3:0xfd
    v_xor_b32 v104, v104, v8
    v_xor_b32 v105, v105, v9
    v_xor_b32 v106, v106, v10
    v_xor_b32 v107, v107, v11
    v_bitop3_b32 v12, v12, v104, v105 bitop3:0xfd
    v_bitop3_b32 v12, v12, v106, v107 bitop3:0xfd
    v_mfma_f32_32x32x16_bf16 v[192:207], v[172:175], v[152:155], 0
    v_and_b32 v13, 30, v104
    v_cmp_ne_u32 vcc, s18, v13
    v_mov_b32 v14, 142464
    s_nop 0
    v_mov_b32 v13, vcc_lo
    ds_write_b32 v14, v13
    s_waitcnt vmcnt(7)
    v_xor_b32 v120, v120, v8
    v_xor_b32 v121, v121, v9
    v_xor_b32 v122, v122, v10
    v_xor_b32 v123, v123, v11
    v_bitop3_b32 v12, v12, v120, v121 bitop3:0xfd
    v_bitop3_b32 v12, v12, v122, v123 bitop3:0xfd
    v_mfma_f32_32x32x16_bf16 v[176:191], v[172:175], v[120:123], 0
    s_waitcnt vmcnt(6)
    v_xor_b32 v124, v124, v8
    v_xor_b32 v125, v125, v9
    v_xor_b32 v126, v126, v10
    v_xor_b32 v127, v127, v11
    v_bitop3_b32 v12, v12, v124, v125 bitop3:0xfd
    v_bitop3_b32 v12, v12, v126, v127 bitop3:0xfd
    v_mfma_f32_32x32x16_bf16 v[176:191], v[172:175], v[124:127], v[176:191]
    v_permlane16_swap_b32 v192, v194
    v_permlane16_swap_b32 v193, v195
    v_add_f32 v192, v192, v194
    v_add_f32 v193, v193, v195
    s_nop 0
    v_add_f32_dpp v192, v192, v192 row_shr:4 row_mask:0xf bank_mask:0xf
    v_add_f32_dpp v193, v193, v193 row_shr:4 row_mask:0xf bank_mask:0xf
    s_nop 0
    v_add_f32_dpp v192, v192, v192 row_shr:8 row_mask:0xf bank_mask:0xf
    v_add_f32_dpp v193, v193, v193 row_shr:8 row_mask:0xf bank_mask:0xf
    v_cvt_pk_bf16_f32 v192, v192, v193
    s_waitcnt vmcnt(5)
    v_xor_b32 v128, v128, v8
    v_xor_b32 v129, v129, v9
    v_xor_b32 v130, v130, v10
    v_xor_b32 v131, v131, v11
    v_bitop3_b32 v12, v12, v128, v129 bitop3:0xfd
    v_bitop3_b32 v12, v12, v130, v131 bitop3:0xfd
    v_mfma_f32_32x32x16_bf16 v[176:191], v[172:175], v[128:131], v[176:191]
    s_waitcnt vmcnt(4)
    v_xor_b32 v132, v132, v8
    v_xor_b32 v133, v133, v9
    v_xor_b32 v134, v134, v10
    v_xor_b32 v135, v135, v11
    v_bitop3_b32 v12, v12, v132, v133 bitop3:0xfd
    v_bitop3_b32 v12, v12, v134, v135 bitop3:0xfd
    v_mfma_f32_32x32x16_bf16 v[176:191], v[172:175], v[132:135], v[176:191]
    s_waitcnt vmcnt(3)
    v_xor_b32 v136, v136, v8
    v_xor_b32 v137, v137, v9
    v_xor_b32 v138, v138, v10
    v_xor_b32 v139, v139, v11
    v_bitop3_b32 v12, v12, v136, v137 bitop3:0xfd
    v_bitop3_b32 v12, v12, v138, v139 bitop3:0xfd
    v_mfma_f32_32x32x16_bf16 v[176:191], v[172:175], v[136:139], v[176:191]
    s_waitcnt vmcnt(2)
    v_xor_b32 v140, v140, v8
    v_xor_b32 v141, v141, v9
    v_xor_b32 v142, v142, v10
    v_xor_b32 v143, v143, v11
    v_bitop3_b32 v12, v12, v140, v141 bitop3:0xfd
    v_bitop3_b32 v12, v12, v142, v143 bitop3:0xfd
    v_mfma_f32_32x32x16_bf16 v[176:191], v[172:175], v[140:143], v[176:191]
    s_waitcnt vmcnt(1)
    v_xor_b32 v144, v144, v8
    v_xor_b32 v145, v145, v9
    v_xor_b32 v146, v146, v10
    v_xor_b32 v147, v147, v11
    v_bitop3_b32 v12, v12, v144, v145 bitop3:0xfd
    v_bitop3_b32 v12, v12, v146, v147 bitop3:0xfd
    v_mfma_f32_32x32x16_bf16 v[176:191], v[172:175], v[144:147], v[176:191]
    s_waitcnt vmcnt(0)
    v_xor_b32 v148, v148, v8
    v_xor_b32 v149, v149, v9
    v_xor_b32 v150, v150, v10
    v_xor_b32 v151, v151, v11
    v_bitop3_b32 v12, v12, v148, v149 bitop3:0xfd
    v_bitop3_b32 v12, v12, v150, v151 bitop3:0xfd
    v_and_b32 v12, s60, v12
    v_cmp_ne_u32 vcc, 0, v12
    v_mfma_f32_32x32x16_bf16 v[176:191], v[172:175], v[148:151], v[176:191]
    s_sub_u32 s61, s61, 1
    s_cbranch_scc1 B_poll1_done
    s_cbranch_vccnz B_poll1
B_poll1_done:
    s_nop 9
    v_cvt_pk_bf16_f32 v156, v176, v177
    v_cvt_pk_bf16_f32 v157, v178, v179
    ds_write_b64 v112, v[156:157]
    s_mov_b32 exec_lo, 0xf000f000
    s_mov_b32 exec_hi, 0xf000f000
    ds_write_b32 v113, v192
    s_mov_b64 exec, -1
    s_waitcnt lgkmcnt(0)
    s_barrier
    s_endpgm
B_compute:
    s_lshr_b32 s59, s3, 1
    s_and_b32 s62, s3, 1
    v_and_b32 v27, 31, v0
    v_lshrrev_b32 v12, 5, v0
    v_bfe_u32 v14, v0, 1, 3
    v_xor_b32 v14, v14, v12
    v_lshlrev_b32 v14, 4, v14
    v_lshl_add_u32 v14, v27, 7, v14
    s_lshl_b32 s44, s3, 12
    v_add_u32 v16, s44, v14
    v_xor_b32 v17, 32, v16
    v_xor_b32 v18, 64, v16
    v_xor_b32 v19, 96, v16
    v_xor_b32 v20, 0x1000, v16
    v_xor_b32 v21, 0x1000, v17
    v_xor_b32 v22, 0x1000, v18
    v_xor_b32 v23, 0x1000, v19
    v_bfe_u32 v14, v0, 2, 2
    v_and_b32 v15, 1, v2
    v_lshlrev_b32 v15, 5, v15
    v_lshl_add_u32 v15, v3, 3, v15
    v_lshl_add_u32 v13, v12, 3, v14
    v_xor_b32 v24, s62, v14
    v_lshl_add_u32 v24, v24, 6, v15
    v_lshl_add_u32 v24, v13, 8, v24
    v_add_u32 v24, 16384, v24
    v_xor_b32 v25, 128, v24
    v_lshrrev_b32 v26, 1, v14
    v_lshl_add_u32 v15, v26, 6, v15
    v_lshl_add_u32 v1, v13, 7, v15
    v_lshl_add_u32 v13, v12, 2, v14
    v_lshl_add_u32 v26, v13, 7, v15
    v_add_u32 v26, 65536, v26
    s_mov_b32 s54, 0x358637bd
    v_mov_b32 v52, s54
    v_mov_b32 v53, s54
    v_mov_b32 v54, s54
    v_mov_b32 v55, s54
    v_mov_b32 v56, s54
    v_mov_b32 v57, s54
    v_mov_b32 v58, s54
    v_mov_b32 v59, s54
    v_mov_b32 v60, s54
    v_mov_b32 v61, s54
    v_mov_b32 v62, s54
    v_mov_b32 v63, s54
    v_mov_b32 v64, s54
    v_mov_b32 v65, s54
    v_mov_b32 v66, s54
    v_mov_b32 v67, s54
    v_mov_b32 v68, s54
    v_mov_b32 v69, s54
    v_mov_b32 v70, s54
    v_mov_b32 v71, s54
    v_mov_b32 v72, s54
    v_mov_b32 v73, s54
    v_mov_b32 v74, s54
    v_mov_b32 v75, s54
    v_mov_b32 v76, s54
    v_mov_b32 v77, s54
    v_mov_b32 v78, s54
    v_mov_b32 v79, s54
    v_mov_b32 v80, s54
    v_mov_b32 v81, s54
    v_mov_b32 v82, s54
    v_mov_b32 v83, s54
    s_waitcnt lgkmcnt(0)
    s_load_dword s22, s[20:21], 256
    s_mov_b32 s36, s16
    s_mov_b32 s37, s17
    s_mov_b32 s38, 0x400000
    s_mov_b32 s39, 0x20000
    s_mov_b32 s40, s20
    s_mov_b32 s41, s21
    s_mov_b32 s42, 0x700000
    s_mov_b32 s43, 0x20000
    s_lshl_b32 s64, s57, 12
    s_lshl_b32 s53, s57, 2
    s_lshl_b32 s49, 1, s53
    s_xor_b32 s49, s49, 0x11111111
    s_add_u32 s53, s53, 4
    s_sub_u32 s51, 384, s12
    s_bfe_u32 s51, s51, 0x30007
    s_lshl_b32 s51, s51, 2
    s_mov_b32 s50, -1
    s_bitset0_b32 s50, s51
    s_and_b32 s51, s50, s49
    s_cselect_b32 s51, s51, s49
    s_lshr_b32 s52, s51, s53
    s_lshl_b32 s52, s52, s53
    s_cselect_b32 s51, s52, s51
    s_ff1_i32_b32 s51, s51
    s_bitset0_b32 s49, s51
    s_lshl_b32 s65, s51, 10
    s_and_b32 s51, s50, s49
    s_cselect_b32 s51, s51, s49
    s_lshr_b32 s52, s51, s53
    s_lshl_b32 s52, s52, s53
    s_cselect_b32 s51, s52, s51
    s_ff1_i32_b32 s51, s51
    s_bitset0_b32 s49, s51
    s_lshl_b32 s66, s51, 10
    s_and_b32 s51, s50, s49
    s_cselect_b32 s51, s51, s49
    s_lshr_b32 s52, s51, s53
    s_lshl_b32 s52, s52, s53
    s_cselect_b32 s51, s52, s51
    s_ff1_i32_b32 s51, s51
    s_bitset0_b32 s49, s51
    s_lshl_b32 s67, s51, 10
    s_and_b32 s51, s50, s49
    s_cselect_b32 s51, s51, s49
    s_lshr_b32 s52, s51, s53
    s_lshl_b32 s52, s52, s53
    s_cselect_b32 s51, s52, s51
    s_ff1_i32_b32 s51, s51
    s_bitset0_b32 s49, s51
    s_lshl_b32 s68, s51, 10
    s_and_b32 s51, s50, s49
    s_cselect_b32 s51, s51, s49
    s_lshr_b32 s52, s51, s53
    s_lshl_b32 s52, s52, s53
    s_cselect_b32 s51, s52, s51
    s_ff1_i32_b32 s51, s51
    s_bitset0_b32 s49, s51
    s_lshl_b32 s69, s51, 10
    s_and_b32 s51, s50, s49
    s_cselect_b32 s51, s51, s49
    s_lshr_b32 s52, s51, s53
    s_lshl_b32 s52, s52, s53
    s_cselect_b32 s51, s52, s51
    s_ff1_i32_b32 s51, s51
    s_bitset0_b32 s49, s51
    s_lshl_b32 s70, s51, 10
    s_and_b32 s51, s50, s49
    s_cselect_b32 s51, s51, s49
    s_lshr_b32 s52, s51, s53
    s_lshl_b32 s52, s52, s53
    s_cselect_b32 s51, s52, s51
    s_ff1_i32_b32 s51, s51
    s_bitset0_b32 s49, s51
    s_lshl_b32 s71, s51, 10
    s_and_b32 s51, s3, 3
    s_lshl_b32 s18, s56, 2
    s_add_u32 s18, s18, s51
    s_lshl_b32 s19, s18, 16
    s_lshl_b32 s51, s57, 7
    s_add_u32 s19, s19, s51
    s_add_u32 s19, s19, 1024
    s_lshl_b32 s18, s18, 15
    s_add_u32 s18, s18, 4390912
    s_mov_b32 s0, 0x3fb8aa3b
    s_mov_b32 s1, s0
    s_lshl_b32 s44, s62, 1
    s_add_u32 s44, s44, s59
    s_lshl_b32 s45, s44, 11
    s_add_u32 s45, s45, 131072
    v_add_u32 v4, s45, v6
    s_lshl_b32 s45, s44, 7
    s_add_u32 s45, s45, 139264
    v_lshl_add_u32 v5, v27, 2, s45
    s_barrier
    ds_read_b128 v[116:119], v16 offset:0
    ds_read_b64_tr_b16 v[36:37], v24 offset:0
    ds_read_b64_tr_b16 v[38:39], v24 offset:1024
    ds_read_b128 v[28:31], v20 offset:0
    ds_read_b64_tr_b16 v[44:45], v25 offset:0
    ds_read_b64_tr_b16 v[46:47], v25 offset:1024
    s_waitcnt lgkmcnt(3)
    v_mfma_f32_32x32x16_bf16 v[52:67], v[116:119], v[36:39], v[52:67]
    ds_read_b128 v[120:123], v17 offset:0
    ds_read_b64_tr_b16 v[40:41], v24 offset:4096
    s_waitcnt lgkmcnt(4)
    v_mfma_f32_32x32x16_bf16 v[68:83], v[28:31], v[36:39], v[68:83]
    ds_read_b64_tr_b16 v[42:43], v24 offset:5120
    ds_read_b128 v[32:35], v21 offset:0
    s_waitcnt lgkmcnt(4)
    v_mfma_f32_32x32x16_bf16 v[84:99], v[116:119], v[44:47], 0
    ds_read_b64_tr_b16 v[48:49], v25 offset:4096
    ds_read_b64_tr_b16 v[50:51], v25 offset:5120
    v_mfma_f32_32x32x16_bf16 v[100:115], v[28:31], v[44:47], 0
    s_waitcnt lgkmcnt(3)
    v_mfma_f32_32x32x16_bf16 v[52:67], v[120:123], v[40:43], v[52:67]
    ds_read_b128 v[124:127], v18 offset:0
    ds_read_b64_tr_b16 v[36:37], v24 offset:8192
    s_waitcnt lgkmcnt(4)
    v_mfma_f32_32x32x16_bf16 v[68:83], v[32:35], v[40:43], v[68:83]
    ds_read_b64_tr_b16 v[38:39], v24 offset:9216
    ds_read_b128 v[28:31], v22 offset:0
    s_waitcnt lgkmcnt(4)
    v_mfma_f32_32x32x16_bf16 v[84:99], v[120:123], v[48:51], v[84:99]
    ds_read_b64_tr_b16 v[44:45], v25 offset:8192
    ds_read_b64_tr_b16 v[46:47], v25 offset:9216
    v_mfma_f32_32x32x16_bf16 v[100:115], v[32:35], v[48:51], v[100:115]
    s_waitcnt lgkmcnt(3)
    v_mfma_f32_32x32x16_bf16 v[52:67], v[124:127], v[36:39], v[52:67]
    ds_read_b128 v[128:131], v19 offset:0
    ds_read_b64_tr_b16 v[40:41], v24 offset:12288
    s_waitcnt lgkmcnt(4)
    v_mfma_f32_32x32x16_bf16 v[68:83], v[28:31], v[36:39], v[68:83]
    ds_read_b64_tr_b16 v[42:43], v24 offset:13312
    ds_read_b128 v[32:35], v23 offset:0
    s_waitcnt lgkmcnt(4)
    v_mfma_f32_32x32x16_bf16 v[84:99], v[124:127], v[44:47], v[84:99]
    ds_read_b64_tr_b16 v[48:49], v25 offset:12288
    ds_read_b64_tr_b16 v[50:51], v25 offset:13312
    v_mfma_f32_32x32x16_bf16 v[100:115], v[28:31], v[44:47], v[100:115]
    s_waitcnt lgkmcnt(3)
    v_mfma_f32_32x32x16_bf16 v[52:67], v[128:131], v[40:43], v[52:67]
    s_barrier
    ds_read_b128 v[132:135], v16 offset:32768
    ds_read_b64_tr_b16 v[36:37], v24 offset:32768
    s_waitcnt lgkmcnt(4)
    v_mfma_f32_32x32x16_bf16 v[68:83], v[32:35], v[40:43], v[68:83]
    ds_read_b64_tr_b16 v[38:39], v24 offset:33792
    ds_read_b128 v[28:31], v20 offset:32768
    s_waitcnt lgkmcnt(4)
    v_mfma_f32_32x32x16_bf16 v[84:99], v[128:131], v[48:51], v[84:99]
    ds_read_b64_tr_b16 v[44:45], v25 offset:32768
    ds_read_b64_tr_b16 v[46:47], v25 offset:33792
    v_mfma_f32_32x32x16_bf16 v[100:115], v[32:35], v[48:51], v[100:115]
    s_waitcnt lgkmcnt(3)
    v_mfma_f32_32x32x16_bf16 v[52:67], v[132:135], v[36:39], v[52:67]
    ds_read_b128 v[136:139], v17 offset:32768
    ds_read_b64_tr_b16 v[40:41], v24 offset:36864
    s_waitcnt lgkmcnt(4)
    v_mfma_f32_32x32x16_bf16 v[68:83], v[28:31], v[36:39], v[68:83]
    ds_read_b64_tr_b16 v[42:43], v24 offset:37888
    ds_read_b128 v[32:35], v21 offset:32768
    s_waitcnt lgkmcnt(4)
    v_mfma_f32_32x32x16_bf16 v[84:99], v[132:135], v[44:47], v[84:99]
    ds_read_b64_tr_b16 v[48:49], v25 offset:36864
    ds_read_b64_tr_b16 v[50:51], v25 offset:37888
    v_mfma_f32_32x32x16_bf16 v[100:115], v[28:31], v[44:47], v[100:115]
    s_waitcnt lgkmcnt(3)
    v_mfma_f32_32x32x16_bf16 v[52:67], v[136:139], v[40:43], v[52:67]
    ds_read_b128 v[140:143], v18 offset:32768
    ds_read_b64_tr_b16 v[36:37], v24 offset:40960
    s_waitcnt lgkmcnt(4)
    v_mfma_f32_32x32x16_bf16 v[68:83], v[32:35], v[40:43], v[68:83]
    ds_read_b64_tr_b16 v[38:39], v24 offset:41984
    ds_read_b128 v[28:31], v22 offset:32768
    s_waitcnt lgkmcnt(4)
    v_mfma_f32_32x32x16_bf16 v[84:99], v[136:139], v[48:51], v[84:99]
    ds_read_b64_tr_b16 v[44:45], v25 offset:40960
    ds_read_b64_tr_b16 v[46:47], v25 offset:41984
    v_mfma_f32_32x32x16_bf16 v[100:115], v[32:35], v[48:51], v[100:115]
    s_waitcnt lgkmcnt(3)
    v_mfma_f32_32x32x16_bf16 v[52:67], v[140:143], v[36:39], v[52:67]
    ds_read_b128 v[144:147], v19 offset:32768
    ds_read_b64_tr_b16 v[40:41], v24 offset:45056
    s_waitcnt lgkmcnt(4)
    v_mfma_f32_32x32x16_bf16 v[68:83], v[28:31], v[36:39], v[68:83]
    ds_read_b64_tr_b16 v[42:43], v24 offset:46080
    ds_read_b128 v[32:35], v23 offset:32768
    s_waitcnt lgkmcnt(4)
    v_mfma_f32_32x32x16_bf16 v[84:99], v[140:143], v[44:47], v[84:99]
    ds_read_b64_tr_b16 v[48:49], v25 offset:45056
    ds_read_b64_tr_b16 v[50:51], v25 offset:46080
    v_mfma_f32_32x32x16_bf16 v[100:115], v[28:31], v[44:47], v[100:115]
    s_waitcnt lgkmcnt(3)
    v_mfma_f32_32x32x16_bf16 v[52:67], v[144:147], v[40:43], v[52:67]
    v_xor_b32 v16, 0x10000, v16
    v_xor_b32 v17, 0x10000, v17
    v_xor_b32 v18, 0x10000, v18
    v_xor_b32 v19, 0x10000, v19
    v_xor_b32 v20, 0x10000, v20
    v_xor_b32 v21, 0x10000, v21
    v_xor_b32 v22, 0x10000, v22
    v_xor_b32 v23, 0x10000, v23
    v_xor_b32 v24, 0x10000, v24
    v_xor_b32 v25, 0x10000, v25
    s_barrier
    ds_read_b128 v[148:151], v16 offset:0
    ds_read_b64_tr_b16 v[36:37], v24 offset:0
    s_waitcnt lgkmcnt(4)
    v_mfma_f32_32x32x16_bf16 v[68:83], v[32:35], v[40:43], v[68:83]
    ds_read_b64_tr_b16 v[38:39], v24 offset:1024
    ds_read_b128 v[28:31], v20 offset:0
    s_waitcnt lgkmcnt(4)
    v_mfma_f32_32x32x16_bf16 v[84:99], v[144:147], v[48:51], v[84:99]
    ds_read_b64_tr_b16 v[44:45], v25 offset:0
    ds_read_b64_tr_b16 v[46:47], v25 offset:1024
    v_mfma_f32_32x32x16_bf16 v[100:115], v[32:35], v[48:51], v[100:115]
    s_waitcnt lgkmcnt(3)
    v_mfma_f32_32x32x16_bf16 v[52:67], v[148:151], v[36:39], v[52:67]
    ds_read_b128 v[152:155], v17 offset:0
    ds_read_b64_tr_b16 v[40:41], v24 offset:4096
    s_waitcnt lgkmcnt(4)
    v_mfma_f32_32x32x16_bf16 v[68:83], v[28:31], v[36:39], v[68:83]
    ds_read_b64_tr_b16 v[42:43], v24 offset:5120
    ds_read_b128 v[32:35], v21 offset:0
    s_waitcnt lgkmcnt(4)
    v_mfma_f32_32x32x16_bf16 v[84:99], v[148:151], v[44:47], v[84:99]
    ds_read_b64_tr_b16 v[48:49], v25 offset:4096
    ds_read_b64_tr_b16 v[50:51], v25 offset:5120
    v_mfma_f32_32x32x16_bf16 v[100:115], v[28:31], v[44:47], v[100:115]
    s_waitcnt lgkmcnt(3)
    v_mfma_f32_32x32x16_bf16 v[52:67], v[152:155], v[40:43], v[52:67]
    ds_read_b128 v[156:159], v18 offset:0
    ds_read_b64_tr_b16 v[36:37], v24 offset:8192
    s_waitcnt lgkmcnt(4)
    v_mfma_f32_32x32x16_bf16 v[68:83], v[32:35], v[40:43], v[68:83]
    ds_read_b64_tr_b16 v[38:39], v24 offset:9216
    ds_read_b128 v[28:31], v22 offset:0
    s_waitcnt lgkmcnt(4)
    v_mfma_f32_32x32x16_bf16 v[84:99], v[152:155], v[48:51], v[84:99]
    ds_read_b64_tr_b16 v[44:45], v25 offset:8192
    ds_read_b64_tr_b16 v[46:47], v25 offset:9216
    v_mfma_f32_32x32x16_bf16 v[100:115], v[32:35], v[48:51], v[100:115]
    s_waitcnt lgkmcnt(3)
    v_mfma_f32_32x32x16_bf16 v[52:67], v[156:159], v[36:39], v[52:67]
    ds_read_b128 v[160:163], v19 offset:0
    ds_read_b64_tr_b16 v[40:41], v24 offset:12288
    s_waitcnt lgkmcnt(4)
    v_mfma_f32_32x32x16_bf16 v[68:83], v[28:31], v[36:39], v[68:83]
    ds_read_b64_tr_b16 v[42:43], v24 offset:13312
    ds_read_b128 v[32:35], v23 offset:0
    s_waitcnt lgkmcnt(4)
    v_mfma_f32_32x32x16_bf16 v[84:99], v[156:159], v[44:47], v[84:99]
    ds_read_b64_tr_b16 v[48:49], v25 offset:12288
    ds_read_b64_tr_b16 v[50:51], v25 offset:13312
    v_mfma_f32_32x32x16_bf16 v[100:115], v[28:31], v[44:47], v[100:115]
    s_waitcnt lgkmcnt(3)
    v_mfma_f32_32x32x16_bf16 v[52:67], v[160:163], v[40:43], v[52:67]
    s_waitcnt lgkmcnt(0)
    s_barrier
    ds_read_b128 v[164:167], v16 offset:32768
    ds_read_b64_tr_b16 v[36:37], v24 offset:32768
    s_waitcnt lgkmcnt(4)
    v_mfma_f32_32x32x16_bf16 v[68:83], v[32:35], v[40:43], v[68:83]
    ds_read_b64_tr_b16 v[38:39], v24 offset:33792
    ds_read_b128 v[28:31], v20 offset:32768
    s_waitcnt lgkmcnt(4)
    v_mfma_f32_32x32x16_bf16 v[84:99], v[160:163], v[48:51], v[84:99]
    ds_read_b64_tr_b16 v[44:45], v25 offset:32768
    ds_read_b64_tr_b16 v[46:47], v25 offset:33792
    v_mfma_f32_32x32x16_bf16 v[100:115], v[32:35], v[48:51], v[100:115]
    v_lshlrev_b32 v12, 3, v3
    s_add_u32 s22, s22, 1
    s_mul_i32 s60, s22, 0x01010101
    s_xor_b32 s60, s60, 0xcccccccc
    v_lshrrev_b32 v14, v12, s60
    s_mov_b32 s60, 0x10001
    v_bfe_u32 v8, v14, 0, 2
    v_bfe_u32 v9, v14, 2, 2
    v_bfe_u32 v10, v14, 4, 2
    v_bfe_u32 v11, v14, 6, 2
    v_lshl_or_b32 v8, v8, 15, v8
    v_lshl_or_b32 v9, v9, 15, v9
    v_lshl_or_b32 v10, v10, 15, v10
    v_lshl_or_b32 v11, v11, 15, v11
    v_and_b32 v8, s60, v8
    v_and_b32 v9, s60, v9
    v_and_b32 v10, s60, v10
    v_and_b32 v11, s60, v11
    s_waitcnt lgkmcnt(3)
    v_mfma_f32_32x32x16_bf16 v[52:67], v[164:167], v[36:39], v[52:67]
    ds_read_b128 v[168:171], v17 offset:32768
    ds_read_b64_tr_b16 v[40:41], v24 offset:36864
    s_waitcnt lgkmcnt(4)
    v_mfma_f32_32x32x16_bf16 v[68:83], v[28:31], v[36:39], v[68:83]
    ds_read_b64_tr_b16 v[42:43], v24 offset:37888
    ds_read_b128 v[32:35], v21 offset:32768
    s_waitcnt lgkmcnt(4)
    v_mfma_f32_32x32x16_bf16 v[84:99], v[164:167], v[44:47], v[84:99]
    ds_read_b64_tr_b16 v[48:49], v25 offset:36864
    ds_read_b64_tr_b16 v[50:51], v25 offset:37888
    v_mfma_f32_32x32x16_bf16 v[100:115], v[28:31], v[44:47], v[100:115]
    s_waitcnt lgkmcnt(3)
    v_mfma_f32_32x32x16_bf16 v[52:67], v[168:171], v[40:43], v[52:67]
    ds_read_b128 v[172:175], v18 offset:32768
    ds_read_b64_tr_b16 v[36:37], v24 offset:40960
    s_waitcnt lgkmcnt(4)
    v_mfma_f32_32x32x16_bf16 v[68:83], v[32:35], v[40:43], v[68:83]
    ds_read_b64_tr_b16 v[38:39], v24 offset:41984
    ds_read_b128 v[28:31], v22 offset:32768
    s_waitcnt lgkmcnt(4)
    v_mfma_f32_32x32x16_bf16 v[84:99], v[168:171], v[48:51], v[84:99]
    ds_read_b64_tr_b16 v[44:45], v25 offset:40960
    ds_read_b64_tr_b16 v[46:47], v25 offset:41984
    v_mfma_f32_32x32x16_bf16 v[100:115], v[32:35], v[48:51], v[100:115]
    s_waitcnt lgkmcnt(3)
    v_mfma_f32_32x32x16_bf16 v[52:67], v[172:175], v[36:39], v[52:67]
    ds_read_b128 v[176:179], v19 offset:32768
    ds_read_b64_tr_b16 v[40:41], v24 offset:45056
    s_waitcnt lgkmcnt(4)
    v_mfma_f32_32x32x16_bf16 v[68:83], v[28:31], v[36:39], v[68:83]
    ds_read_b64_tr_b16 v[42:43], v24 offset:46080
    ds_read_b128 v[32:35], v23 offset:32768
    s_waitcnt lgkmcnt(4)
    v_mfma_f32_32x32x16_bf16 v[84:99], v[172:175], v[44:47], v[84:99]
    ds_read_b64_tr_b16 v[48:49], v25 offset:45056
    ds_read_b64_tr_b16 v[50:51], v25 offset:46080
    v_mfma_f32_32x32x16_bf16 v[100:115], v[28:31], v[44:47], v[100:115]
    s_waitcnt lgkmcnt(3)
    v_mfma_f32_32x32x16_bf16 v[52:67], v[176:179], v[40:43], v[52:67]
    v_xor_b32 v16, 0x10000, v16
    v_xor_b32 v17, 0x10000, v17
    v_xor_b32 v18, 0x10000, v18
    v_xor_b32 v19, 0x10000, v19
    v_xor_b32 v20, 0x10000, v20
    v_xor_b32 v21, 0x10000, v21
    v_xor_b32 v22, 0x10000, v22
    v_xor_b32 v23, 0x10000, v23
    v_xor_b32 v24, 0x10000, v24
    v_xor_b32 v25, 0x10000, v25
    s_barrier
    ds_read_b128 v[180:183], v16 offset:0
    ds_read_b64_tr_b16 v[36:37], v24 offset:0
    s_waitcnt lgkmcnt(4)
    v_mfma_f32_32x32x16_bf16 v[68:83], v[32:35], v[40:43], v[68:83]
    ds_read_b64_tr_b16 v[38:39], v24 offset:1024
    ds_read_b128 v[28:31], v20 offset:0
    s_waitcnt lgkmcnt(4)
    v_mfma_f32_32x32x16_bf16 v[84:99], v[176:179], v[48:51], v[84:99]
    ds_read_b64_tr_b16 v[44:45], v25 offset:0
    ds_read_b64_tr_b16 v[46:47], v25 offset:1024
    v_mfma_f32_32x32x16_bf16 v[100:115], v[32:35], v[48:51], v[100:115]
    s_waitcnt lgkmcnt(3)
    v_mfma_f32_32x32x16_bf16 v[52:67], v[180:183], v[36:39], v[52:67]
    ds_read_b128 v[184:187], v17 offset:0
    ds_read_b64_tr_b16 v[40:41], v24 offset:4096
    s_waitcnt lgkmcnt(4)
    v_mfma_f32_32x32x16_bf16 v[68:83], v[28:31], v[36:39], v[68:83]
    ds_read_b64_tr_b16 v[42:43], v24 offset:5120
    ds_read_b128 v[32:35], v21 offset:0
    s_waitcnt lgkmcnt(4)
    v_mfma_f32_32x32x16_bf16 v[84:99], v[180:183], v[44:47], v[84:99]
    ds_read_b64_tr_b16 v[48:49], v25 offset:4096
    ds_read_b64_tr_b16 v[50:51], v25 offset:5120
    v_mfma_f32_32x32x16_bf16 v[100:115], v[28:31], v[44:47], v[100:115]
    s_waitcnt lgkmcnt(3)
    v_mfma_f32_32x32x16_bf16 v[52:67], v[184:187], v[40:43], v[52:67]
    ds_read_b128 v[188:191], v18 offset:0
    ds_read_b64_tr_b16 v[36:37], v24 offset:8192
    s_waitcnt lgkmcnt(4)
    v_mfma_f32_32x32x16_bf16 v[68:83], v[32:35], v[40:43], v[68:83]
    ds_read_b64_tr_b16 v[38:39], v24 offset:9216
    ds_read_b128 v[28:31], v22 offset:0
    s_waitcnt lgkmcnt(4)
    v_mfma_f32_32x32x16_bf16 v[84:99], v[184:187], v[48:51], v[84:99]
    ds_read_b64_tr_b16 v[44:45], v25 offset:8192
    ds_read_b64_tr_b16 v[46:47], v25 offset:9216
    v_mfma_f32_32x32x16_bf16 v[100:115], v[32:35], v[48:51], v[100:115]
    s_waitcnt lgkmcnt(3)
    v_mfma_f32_32x32x16_bf16 v[52:67], v[188:191], v[36:39], v[52:67]
    ds_read_b128 v[192:195], v19 offset:0
    ds_read_b64_tr_b16 v[40:41], v24 offset:12288
    s_waitcnt lgkmcnt(4)
    v_mfma_f32_32x32x16_bf16 v[68:83], v[28:31], v[36:39], v[68:83]
    ds_read_b64_tr_b16 v[42:43], v24 offset:13312
    ds_read_b128 v[32:35], v23 offset:0
    s_waitcnt lgkmcnt(4)
    v_mfma_f32_32x32x16_bf16 v[84:99], v[188:191], v[44:47], v[84:99]
    ds_read_b64_tr_b16 v[48:49], v25 offset:12288
    ds_read_b64_tr_b16 v[50:51], v25 offset:13312
    v_mfma_f32_32x32x16_bf16 v[100:115], v[28:31], v[44:47], v[100:115]
    s_waitcnt lgkmcnt(3)
    v_mfma_f32_32x32x16_bf16 v[52:67], v[192:195], v[40:43], v[52:67]
    s_barrier
    ds_read_b128 v[196:199], v16 offset:32768
    ds_read_b64_tr_b16 v[36:37], v24 offset:32768
    s_waitcnt lgkmcnt(4)
    v_mfma_f32_32x32x16_bf16 v[68:83], v[32:35], v[40:43], v[68:83]
    ds_read_b64_tr_b16 v[38:39], v24 offset:33792
    ds_read_b128 v[28:31], v20 offset:32768
    s_waitcnt lgkmcnt(4)
    v_mfma_f32_32x32x16_bf16 v[84:99], v[192:195], v[48:51], v[84:99]
    ds_read_b64_tr_b16 v[44:45], v25 offset:32768
    ds_read_b64_tr_b16 v[46:47], v25 offset:33792
    v_mfma_f32_32x32x16_bf16 v[100:115], v[32:35], v[48:51], v[100:115]
    s_waitcnt lgkmcnt(3)
    v_mfma_f32_32x32x16_bf16 v[52:67], v[196:199], v[36:39], v[52:67]
    ds_read_b128 v[200:203], v17 offset:32768
    ds_read_b64_tr_b16 v[40:41], v24 offset:36864
    s_waitcnt lgkmcnt(4)
    v_mfma_f32_32x32x16_bf16 v[68:83], v[28:31], v[36:39], v[68:83]
    ds_read_b64_tr_b16 v[42:43], v24 offset:37888
    ds_read_b128 v[32:35], v21 offset:32768
    s_waitcnt lgkmcnt(4)
    v_mfma_f32_32x32x16_bf16 v[84:99], v[196:199], v[44:47], v[84:99]
    ds_read_b64_tr_b16 v[48:49], v25 offset:36864
    ds_read_b64_tr_b16 v[50:51], v25 offset:37888
    v_mfma_f32_32x32x16_bf16 v[100:115], v[28:31], v[44:47], v[100:115]
    s_waitcnt lgkmcnt(3)
    v_mfma_f32_32x32x16_bf16 v[52:67], v[200:203], v[40:43], v[52:67]
    ds_read_b128 v[204:207], v18 offset:32768
    ds_read_b64_tr_b16 v[36:37], v24 offset:40960
    s_waitcnt lgkmcnt(4)
    v_mfma_f32_32x32x16_bf16 v[68:83], v[32:35], v[40:43], v[68:83]
    ds_read_b64_tr_b16 v[38:39], v24 offset:41984
    ds_read_b128 v[28:31], v22 offset:32768
    s_waitcnt lgkmcnt(4)
    v_mfma_f32_32x32x16_bf16 v[84:99], v[200:203], v[48:51], v[84:99]
    ds_read_b64_tr_b16 v[44:45], v25 offset:40960
    ds_read_b64_tr_b16 v[46:47], v25 offset:41984
    v_mfma_f32_32x32x16_bf16 v[100:115], v[32:35], v[48:51], v[100:115]
    s_waitcnt lgkmcnt(3)
    v_mfma_f32_32x32x16_bf16 v[52:67], v[204:207], v[36:39], v[52:67]
    ds_read_b128 v[208:211], v19 offset:32768
    ds_read_b64_tr_b16 v[40:41], v24 offset:45056
    s_waitcnt lgkmcnt(4)
    v_mfma_f32_32x32x16_bf16 v[68:83], v[28:31], v[36:39], v[68:83]
    ds_read_b64_tr_b16 v[42:43], v24 offset:46080
    ds_read_b128 v[32:35], v23 offset:32768
    s_waitcnt lgkmcnt(4)
    v_mfma_f32_32x32x16_bf16 v[84:99], v[204:207], v[44:47], v[84:99]
    ds_read_b64_tr_b16 v[48:49], v25 offset:45056
    ds_read_b64_tr_b16 v[50:51], v25 offset:46080
    v_mfma_f32_32x32x16_bf16 v[100:115], v[28:31], v[44:47], v[100:115]
    s_waitcnt lgkmcnt(3)
    v_mfma_f32_32x32x16_bf16 v[52:67], v[208:211], v[40:43], v[52:67]
    v_xor_b32 v16, 0x10000, v16
    v_xor_b32 v17, 0x10000, v17
    v_xor_b32 v18, 0x10000, v18
    v_xor_b32 v19, 0x10000, v19
    v_xor_b32 v20, 0x10000, v20
    v_xor_b32 v21, 0x10000, v21
    v_xor_b32 v22, 0x10000, v22
    v_xor_b32 v23, 0x10000, v23
    v_xor_b32 v24, 0x10000, v24
    v_xor_b32 v25, 0x10000, v25
    s_barrier
    ds_read_b128 v[212:215], v16 offset:0
    ds_read_b64_tr_b16 v[36:37], v24 offset:0
    s_waitcnt lgkmcnt(4)
    v_mfma_f32_32x32x16_bf16 v[68:83], v[32:35], v[40:43], v[68:83]
    ds_read_b64_tr_b16 v[38:39], v24 offset:1024
    ds_read_b128 v[28:31], v20 offset:0
    s_waitcnt lgkmcnt(4)
    v_mfma_f32_32x32x16_bf16 v[84:99], v[208:211], v[48:51], v[84:99]
    ds_read_b64_tr_b16 v[44:45], v25 offset:0
    ds_read_b64_tr_b16 v[46:47], v25 offset:1024
    v_mfma_f32_32x32x16_bf16 v[100:115], v[32:35], v[48:51], v[100:115]
    s_waitcnt lgkmcnt(3)
    v_mfma_f32_32x32x16_bf16 v[52:67], v[212:215], v[36:39], v[52:67]
    ds_read_b128 v[216:219], v17 offset:0
    ds_read_b64_tr_b16 v[40:41], v24 offset:4096
    s_waitcnt lgkmcnt(4)
    v_mfma_f32_32x32x16_bf16 v[68:83], v[28:31], v[36:39], v[68:83]
    ds_read_b64_tr_b16 v[42:43], v24 offset:5120
    ds_read_b128 v[32:35], v21 offset:0
    s_waitcnt lgkmcnt(4)
    v_mfma_f32_32x32x16_bf16 v[84:99], v[212:215], v[44:47], v[84:99]
    ds_read_b64_tr_b16 v[48:49], v25 offset:4096
    ds_read_b64_tr_b16 v[50:51], v25 offset:5120
    v_mfma_f32_32x32x16_bf16 v[100:115], v[28:31], v[44:47], v[100:115]
    s_waitcnt lgkmcnt(3)
    v_mfma_f32_32x32x16_bf16 v[52:67], v[216:219], v[40:43], v[52:67]
    ds_read_b128 v[220:223], v18 offset:0
    ds_read_b64_tr_b16 v[36:37], v24 offset:8192
    s_waitcnt lgkmcnt(4)
    v_mfma_f32_32x32x16_bf16 v[68:83], v[32:35], v[40:43], v[68:83]
    ds_read_b64_tr_b16 v[38:39], v24 offset:9216
    ds_read_b128 v[28:31], v22 offset:0
    s_waitcnt lgkmcnt(4)
    v_mfma_f32_32x32x16_bf16 v[84:99], v[216:219], v[48:51], v[84:99]
    ds_read_b64_tr_b16 v[44:45], v25 offset:8192
    ds_read_b64_tr_b16 v[46:47], v25 offset:9216
    v_mfma_f32_32x32x16_bf16 v[100:115], v[32:35], v[48:51], v[100:115]
    s_waitcnt lgkmcnt(3)
    v_mfma_f32_32x32x16_bf16 v[52:67], v[220:223], v[36:39], v[52:67]
    ds_read_b128 v[224:227], v19 offset:0
    ds_read_b64_tr_b16 v[40:41], v24 offset:12288
    s_waitcnt lgkmcnt(4)
    v_mfma_f32_32x32x16_bf16 v[68:83], v[28:31], v[36:39], v[68:83]
    ds_read_b64_tr_b16 v[42:43], v24 offset:13312
    ds_read_b128 v[32:35], v23 offset:0
    s_waitcnt lgkmcnt(4)
    v_mfma_f32_32x32x16_bf16 v[84:99], v[220:223], v[44:47], v[84:99]
    ds_read_b64_tr_b16 v[48:49], v25 offset:12288
    ds_read_b64_tr_b16 v[50:51], v25 offset:13312
    v_mfma_f32_32x32x16_bf16 v[100:115], v[28:31], v[44:47], v[100:115]
    s_waitcnt lgkmcnt(3)
    v_mfma_f32_32x32x16_bf16 v[52:67], v[224:227], v[40:43], v[52:67]
    s_barrier
    ds_read_b128 v[228:231], v16 offset:32768
    ds_read_b64_tr_b16 v[36:37], v24 offset:32768
    s_waitcnt lgkmcnt(4)
    v_mfma_f32_32x32x16_bf16 v[68:83], v[32:35], v[40:43], v[68:83]
    ds_read_b64_tr_b16 v[38:39], v24 offset:33792
    ds_read_b128 v[28:31], v20 offset:32768
    s_waitcnt lgkmcnt(4)
    v_mfma_f32_32x32x16_bf16 v[84:99], v[224:227], v[48:51], v[84:99]
    ds_read_b64_tr_b16 v[44:45], v25 offset:32768
    ds_read_b64_tr_b16 v[46:47], v25 offset:33792
    v_mfma_f32_32x32x16_bf16 v[100:115], v[32:35], v[48:51], v[100:115]
    s_waitcnt lgkmcnt(3)
    v_mfma_f32_32x32x16_bf16 v[52:67], v[228:231], v[36:39], v[52:67]
    ds_read_b128 v[232:235], v17 offset:32768
    ds_read_b64_tr_b16 v[40:41], v24 offset:36864
    s_waitcnt lgkmcnt(4)
    v_mfma_f32_32x32x16_bf16 v[68:83], v[28:31], v[36:39], v[68:83]
    ds_read_b64_tr_b16 v[42:43], v24 offset:37888
    ds_read_b128 v[32:35], v21 offset:32768
    s_waitcnt lgkmcnt(4)
    v_mfma_f32_32x32x16_bf16 v[84:99], v[228:231], v[44:47], v[84:99]
    ds_read_b64_tr_b16 v[48:49], v25 offset:36864
    ds_read_b64_tr_b16 v[50:51], v25 offset:37888
    v_mfma_f32_32x32x16_bf16 v[100:115], v[28:31], v[44:47], v[100:115]
    s_waitcnt lgkmcnt(3)
    v_mfma_f32_32x32x16_bf16 v[52:67], v[232:235], v[40:43], v[52:67]
    ds_read_b128 v[236:239], v18 offset:32768
    ds_read_b64_tr_b16 v[36:37], v24 offset:40960
    s_waitcnt lgkmcnt(4)
    v_mfma_f32_32x32x16_bf16 v[68:83], v[32:35], v[40:43], v[68:83]
    ds_read_b64_tr_b16 v[38:39], v24 offset:41984
    ds_read_b128 v[28:31], v22 offset:32768
    s_waitcnt lgkmcnt(4)
    v_mfma_f32_32x32x16_bf16 v[84:99], v[232:235], v[48:51], v[84:99]
    ds_read_b64_tr_b16 v[44:45], v25 offset:40960
    ds_read_b64_tr_b16 v[46:47], v25 offset:41984
    v_mfma_f32_32x32x16_bf16 v[100:115], v[32:35], v[48:51], v[100:115]
    s_waitcnt lgkmcnt(3)
    v_mfma_f32_32x32x16_bf16 v[52:67], v[236:239], v[36:39], v[52:67]
    ds_read_b128 v[240:243], v19 offset:32768
    ds_read_b64_tr_b16 v[40:41], v24 offset:45056
    s_waitcnt lgkmcnt(4)
    v_mfma_f32_32x32x16_bf16 v[68:83], v[28:31], v[36:39], v[68:83]
    ds_read_b64_tr_b16 v[42:43], v24 offset:46080
    ds_read_b128 v[32:35], v23 offset:32768
    ds_read_b64_tr_b16 v[48:49], v25 offset:45056
    ds_read_b64_tr_b16 v[50:51], v25 offset:46080
    s_waitcnt lgkmcnt(6)
    v_mfma_f32_32x32x16_bf16 v[84:99], v[236:239], v[44:47], v[84:99]
    s_waitcnt lgkmcnt(3)
    v_mfma_f32_32x32x16_bf16 v[52:67], v[240:243], v[40:43], v[52:67]
    s_waitcnt lgkmcnt(2)
    v_mfma_f32_32x32x16_bf16 v[68:83], v[32:35], v[40:43], v[68:83]
    v_mfma_f32_32x32x16_bf16 v[100:115], v[28:31], v[44:47], v[100:115]
    s_waitcnt lgkmcnt(0)
    v_mfma_f32_32x32x16_bf16 v[84:99], v[240:243], v[48:51], v[84:99]
    s_nop 6
    v_mul_f32 v244, s0, v52
    v_mul_f32 v245, s0, v53
    v_mul_f32 v246, s0, v54
    v_mul_f32 v247, s0, v55
    v_exp_f32_e64 v244, v244 clamp
    v_exp_f32_e64 v245, v245 clamp
    v_mfma_f32_32x32x16_bf16 v[100:115], v[32:35], v[48:51], v[100:115]
    v_exp_f32_e64 v246, v246 clamp
    v_exp_f32_e64 v247, v247 clamp
    v_max_f32 v52, s54, v52
    v_max_f32 v53, s54, v53
    v_max_f32 v54, s54, v54
    v_max_f32 v55, s54, v55
    v_add_f32 v52, v52, v244
    v_add_f32 v53, v53, v245
    v_add_f32 v54, v54, v246
    v_add_f32 v55, v55, v247
    v_cvt_pk_bf16_f32 v52, v52, v53
    v_cvt_pk_bf16_f32 v53, v54, v55
    v_mul_f32 v248, s0, v56
    v_mul_f32 v249, s0, v57
    v_mul_f32 v250, s0, v58
    v_mul_f32 v251, s0, v59
    v_exp_f32_e64 v248, v248 clamp
    v_exp_f32_e64 v249, v249 clamp
    v_exp_f32_e64 v250, v250 clamp
    v_exp_f32_e64 v251, v251 clamp
    v_max_f32 v56, s54, v56
    v_max_f32 v57, s54, v57
    v_max_f32 v58, s54, v58
    v_max_f32 v59, s54, v59
    v_add_f32 v56, v56, v248
    v_add_f32 v57, v57, v249
    v_add_f32 v58, v58, v250
    v_add_f32 v59, v59, v251
    v_cvt_pk_bf16_f32 v54, v56, v57
    v_cvt_pk_bf16_f32 v55, v58, v59
    v_mul_f32 v244, s0, v60
    v_mul_f32 v245, s0, v61
    v_mul_f32 v246, s0, v62
    v_mul_f32 v247, s0, v63
    v_exp_f32_e64 v244, v244 clamp
    v_exp_f32_e64 v245, v245 clamp
    v_exp_f32_e64 v246, v246 clamp
    v_exp_f32_e64 v247, v247 clamp
    v_max_f32 v60, s54, v60
    v_max_f32 v61, s54, v61
    v_max_f32 v62, s54, v62
    v_max_f32 v63, s54, v63
    v_add_f32 v60, v60, v244
    v_add_f32 v61, v61, v245
    v_add_f32 v62, v62, v246
    v_add_f32 v63, v63, v247
    v_cvt_pk_bf16_f32 v56, v60, v61
    v_cvt_pk_bf16_f32 v57, v62, v63
    v_mul_f32 v248, s0, v64
    v_mul_f32 v249, s0, v65
    v_mul_f32 v250, s0, v66
    v_mul_f32 v251, s0, v67
    v_exp_f32_e64 v248, v248 clamp
    v_exp_f32_e64 v249, v249 clamp
    v_exp_f32_e64 v250, v250 clamp
    v_exp_f32_e64 v251, v251 clamp
    v_max_f32 v64, s54, v64
    v_max_f32 v65, s54, v65
    v_max_f32 v66, s54, v66
    v_max_f32 v67, s54, v67
    v_add_f32 v64, v64, v248
    v_add_f32 v65, v65, v249
    v_add_f32 v66, v66, v250
    v_add_f32 v67, v67, v251
    v_cvt_pk_bf16_f32 v58, v64, v65
    v_cvt_pk_bf16_f32 v59, v66, v67
    v_mov_b32 v28, 0x3f803f80
    v_mov_b32 v29, 0x3f803f80
    v_mov_b32 v30, 0x3f803f80
    v_mov_b32 v31, 0x3f803f80
    v_cvt_pk_bf16_f32 v84, v84, v85
    v_cvt_pk_bf16_f32 v85, v86, v87
    v_cvt_pk_bf16_f32 v86, v88, v89
    v_cvt_pk_bf16_f32 v87, v90, v91
    v_cvt_pk_bf16_f32 v88, v92, v93
    v_cvt_pk_bf16_f32 v89, v94, v95
    v_cvt_pk_bf16_f32 v90, v96, v97
    v_cvt_pk_bf16_f32 v91, v98, v99
    v_mfma_f32_32x32x16_bf16 v[36:51], v[52:55], v[84:87], 0
    v_cvt_pk_bf16_f32 v92, v100, v101
    v_cvt_pk_bf16_f32 v93, v102, v103
    v_cvt_pk_bf16_f32 v94, v104, v105
    v_cvt_pk_bf16_f32 v95, v106, v107
    v_cvt_pk_bf16_f32 v96, v108, v109
    v_cvt_pk_bf16_f32 v97, v110, v111
    v_cvt_pk_bf16_f32 v98, v112, v113
    v_cvt_pk_bf16_f32 v99, v114, v115
    v_mfma_f32_32x32x16_bf16 v[36:51], v[56:59], v[88:91], v[36:51]
    v_mul_f32 v244, s0, v68
    v_mul_f32 v245, s0, v69
    v_mul_f32 v246, s0, v70
    v_mul_f32 v247, s0, v71
    v_exp_f32_e64 v244, v244 clamp
    v_exp_f32_e64 v245, v245 clamp
    v_exp_f32_e64 v246, v246 clamp
    v_exp_f32_e64 v247, v247 clamp
    v_mfma_f32_32x32x16_bf16 v[100:115], v[28:31], v[52:55], 0
    v_max_f32 v68, s54, v68
    v_max_f32 v69, s54, v69
    v_max_f32 v70, s54, v70
    v_max_f32 v71, s54, v71
    v_add_f32 v68, v68, v244
    v_add_f32 v69, v69, v245
    v_add_f32 v70, v70, v246
    v_add_f32 v71, v71, v247
    v_cvt_pk_bf16_f32 v60, v68, v69
    v_cvt_pk_bf16_f32 v61, v70, v71
    v_mfma_f32_32x32x16_bf16 v[100:115], v[28:31], v[56:59], v[100:115]
    v_mul_f32 v248, s0, v72
    v_mul_f32 v249, s0, v73
    v_mul_f32 v250, s0, v74
    v_mul_f32 v251, s0, v75
    v_exp_f32_e64 v248, v248 clamp
    v_exp_f32_e64 v249, v249 clamp
    v_exp_f32_e64 v250, v250 clamp
    v_exp_f32_e64 v251, v251 clamp
    v_max_f32 v72, s54, v72
    v_max_f32 v73, s54, v73
    v_max_f32 v74, s54, v74
    v_max_f32 v75, s54, v75
    v_add_f32 v72, v72, v248
    v_add_f32 v73, v73, v249
    v_add_f32 v74, v74, v250
    v_add_f32 v75, v75, v251
    v_cvt_pk_bf16_f32 v62, v72, v73
    v_cvt_pk_bf16_f32 v63, v74, v75
    v_mul_f32 v244, s0, v76
    v_mul_f32 v245, s0, v77
    v_mul_f32 v246, s0, v78
    v_mul_f32 v247, s0, v79
    v_mfma_f32_32x32x16_bf16 v[36:51], v[60:63], v[92:95], v[36:51]
    v_exp_f32_e64 v244, v244 clamp
    v_exp_f32_e64 v245, v245 clamp
    v_exp_f32_e64 v246, v246 clamp
    v_exp_f32_e64 v247, v247 clamp
    v_max_f32 v76, s54, v76
    v_max_f32 v77, s54, v77
    v_max_f32 v78, s54, v78
    v_max_f32 v79, s54, v79
    v_mfma_f32_32x32x16_bf16 v[100:115], v[28:31], v[60:63], v[100:115]
    v_add_f32 v76, v76, v244
    v_add_f32 v77, v77, v245
    v_add_f32 v78, v78, v246
    v_add_f32 v79, v79, v247
    v_cvt_pk_bf16_f32 v64, v76, v77
    v_cvt_pk_bf16_f32 v65, v78, v79
    v_mul_f32 v248, s0, v80
    v_mul_f32 v249, s0, v81
    v_mul_f32 v250, s0, v82
    v_mul_f32 v251, s0, v83
    v_exp_f32_e64 v248, v248 clamp
    v_exp_f32_e64 v249, v249 clamp
    v_exp_f32_e64 v250, v250 clamp
    v_exp_f32_e64 v251, v251 clamp
    v_max_f32 v80, s54, v80
    v_max_f32 v81, s54, v81
    v_max_f32 v82, s54, v82
    v_max_f32 v83, s54, v83
    v_add_f32 v80, v80, v248
    v_add_f32 v81, v81, v249
    v_add_f32 v82, v82, v250
    v_add_f32 v83, v83, v251
    v_cvt_pk_bf16_f32 v66, v80, v81
    v_cvt_pk_bf16_f32 v67, v82, v83
    s_nop 1
    v_mfma_f32_32x32x16_bf16 v[36:51], v[64:67], v[96:99], v[36:51]
    v_mfma_f32_32x32x16_bf16 v[100:115], v[28:31], v[64:67], v[100:115]
    v_mov_b32 v20, v1
    v_xor_b32 v21, 64, v1
    s_mov_b32 exec_lo, 0xffff
    s_mov_b32 exec_hi, 0xffff
    s_nop 6
    ds_write_b128 v4, v[36:39]
    ds_write_b128 v4, v[40:43] offset:1024
    s_not_b64 exec, exec
    ds_write_b128 v4, v[44:47]
    ds_write_b128 v4, v[48:51] offset:1024
    s_mov_b64 exec, -1
    ds_write_b32 v5, v100
    v_mov_b32 v52, s54
    v_mov_b32 v53, s54
    v_mov_b32 v54, s54
    v_mov_b32 v55, s54
    v_mov_b32 v56, s54
    v_mov_b32 v57, s54
    v_mov_b32 v58, s54
    v_mov_b32 v59, s54
    v_mov_b32 v60, s54
    v_mov_b32 v61, s54
    v_mov_b32 v62, s54
    v_mov_b32 v63, s54
    v_mov_b32 v64, s54
    v_mov_b32 v65, s54
    v_mov_b32 v66, s54
    v_mov_b32 v67, s54
    s_waitcnt lgkmcnt(0)
    s_barrier
    ds_read_b64_tr_b16 v[36:37], v20 offset:0
    ds_read_b64_tr_b16 v[38:39], v20 offset:512
    ds_read_b64_tr_b16 v[40:41], v20 offset:2048
    ds_read_b64_tr_b16 v[42:43], v20 offset:2560
    ds_read_b64_tr_b16 v[44:45], v20 offset:4096
    ds_read_b64_tr_b16 v[46:47], v20 offset:4608
    ds_read_b64_tr_b16 v[48:49], v20 offset:6144
    ds_read_b64_tr_b16 v[50:51], v20 offset:6656
    v_mov_b32 v84, s54
    v_mov_b32 v85, s54
    v_mov_b32 v86, s54
    v_mov_b32 v87, s54
    v_mov_b32 v88, s54
    v_mov_b32 v89, s54
    v_mov_b32 v90, s54
    v_mov_b32 v91, s54
    v_mov_b32 v92, s54
    v_mov_b32 v93, s54
    v_mov_b32 v94, s54
    v_mov_b32 v95, s54
    v_mov_b32 v96, s54
    v_mov_b32 v97, s54
    v_mov_b32 v98, s54
    v_mov_b32 v99, s54
    s_waitcnt lgkmcnt(4)
    v_mfma_f32_32x32x16_bf16 v[52:67], v[36:39], v[116:119], v[52:67]
    ds_read_b64_tr_b16 v[28:29], v20 offset:8192
    ds_read_b64_tr_b16 v[30:31], v20 offset:8704
    v_add_u32 v12, 140288, v6
    v_lshrrev_b32 v14, 1, v2
    v_mfma_f32_32x32x16_bf16 v[52:67], v[40:43], v[120:123], v[52:67]
    ds_read_b64_tr_b16 v[32:33], v20 offset:10240
    ds_read_b64_tr_b16 v[34:35], v20 offset:10752
    v_lshlrev_b32 v14, 4, v14
    v_add_u32 v14, 142336, v14
    s_waitcnt lgkmcnt(4)
    v_mfma_f32_32x32x16_bf16 v[52:67], v[44:47], v[124:127], v[52:67]
    ds_read_b64_tr_b16 v[36:37], v20 offset:12288
    ds_read_b64_tr_b16 v[38:39], v20 offset:12800
    v_add_u32 v15, 32, v14
    v_and_b32 v13, 1, v2
    v_mfma_f32_32x32x16_bf16 v[52:67], v[48:51], v[128:131], v[52:67]
    ds_read_b64_tr_b16 v[40:41], v20 offset:14336
    ds_read_b64_tr_b16 v[42:43], v20 offset:14848
    v_cmp_eq_u32 vcc, 0, v13
    v_mov_b32 v13, 1024
    s_waitcnt lgkmcnt(4)
    v_mfma_f32_32x32x16_bf16 v[52:67], v[28:31], v[132:135], v[52:67]
    ds_read_b64_tr_b16 v[44:45], v20 offset:16384
    ds_read_b64_tr_b16 v[46:47], v20 offset:16896
    v_cndmask_b32 v4, v14, v12, vcc
    v_cndmask_b32 v5, v12, v15, vcc
    v_mfma_f32_32x32x16_bf16 v[52:67], v[32:35], v[136:139], v[52:67]
    ds_read_b64_tr_b16 v[48:49], v20 offset:18432
    ds_read_b64_tr_b16 v[50:51], v20 offset:18944
    v_cndmask_b32 v14, 64, v13, vcc
    v_add_u32 v24, v4, v14
    s_waitcnt lgkmcnt(4)
    v_mfma_f32_32x32x16_bf16 v[52:67], v[36:39], v[140:143], v[52:67]
    ds_read_b64_tr_b16 v[28:29], v20 offset:20480
    ds_read_b64_tr_b16 v[30:31], v20 offset:20992
    v_sub_u32 v14, 1088, v14
    v_add_u32 v25, v5, v14
    v_mfma_f32_32x32x16_bf16 v[52:67], v[40:43], v[144:147], v[52:67]
    ds_read_b64_tr_b16 v[32:33], v20 offset:22528
    ds_read_b64_tr_b16 v[34:35], v20 offset:23040
    s_add_u32 s44, s64, s18
    v_lshrrev_b32 v12, 5, v0
    s_waitcnt lgkmcnt(4)
    v_mfma_f32_32x32x16_bf16 v[52:67], v[44:47], v[148:151], v[52:67]
    ds_read_b64_tr_b16 v[36:37], v20 offset:24576
    ds_read_b64_tr_b16 v[38:39], v20 offset:25088
    v_lshlrev_b32 v12, 4, v12
    v_and_b32 v18, 31, v0
    v_mfma_f32_32x32x16_bf16 v[52:67], v[48:51], v[152:155], v[52:67]
    ds_read_b64_tr_b16 v[40:41], v20 offset:26624
    ds_read_b64_tr_b16 v[42:43], v20 offset:27136
    v_lshl_add_u32 v18, v18, 11, v12
    s_lshl_b32 s48, s3, 12
    s_waitcnt lgkmcnt(4)
    v_mfma_f32_32x32x16_bf16 v[52:67], v[28:31], v[156:159], v[52:67]
    ds_read_b64_tr_b16 v[44:45], v20 offset:28672
    ds_read_b64_tr_b16 v[46:47], v20 offset:29184
    v_lshrrev_b32 v12, 5, v0
    v_and_b32 v13, 7, v0
    v_mfma_f32_32x32x16_bf16 v[52:67], v[32:35], v[160:163], v[52:67]
    ds_read_b64_tr_b16 v[48:49], v20 offset:30720
    ds_read_b64_tr_b16 v[50:51], v20 offset:31232
    v_lshlrev_b32 v12, 3, v12
    v_lshl_add_u32 v12, v13, 4, v12
    s_waitcnt lgkmcnt(4)
    v_mfma_f32_32x32x16_bf16 v[52:67], v[36:39], v[164:167], v[52:67]
    ds_read_b64_tr_b16 v[28:29], v20 offset:32768
    ds_read_b64_tr_b16 v[30:31], v20 offset:33280
    v_lshl_add_u32 v12, v27, 7, v12
    v_add_u32 v22, s48, v12
    v_mfma_f32_32x32x16_bf16 v[52:67], v[40:43], v[168:171], v[52:67]
    ds_read_b64_tr_b16 v[32:33], v20 offset:34816
    ds_read_b64_tr_b16 v[34:35], v20 offset:35328
    v_xor_b32 v23, 32, v22
    v_xor_b32 v27, 64, v22
    s_waitcnt lgkmcnt(4)
    v_mfma_f32_32x32x16_bf16 v[52:67], v[44:47], v[172:175], v[52:67]
    ds_read_b64_tr_b16 v[36:37], v20 offset:36864
    ds_read_b64_tr_b16 v[38:39], v20 offset:37376
    v_xor_b32 v1, 96, v22
    v_lshrrev_b32 v12, 3, v0
    v_mfma_f32_32x32x16_bf16 v[52:67], v[48:51], v[176:179], v[52:67]
    ds_read_b64_tr_b16 v[40:41], v20 offset:38912
    ds_read_b64_tr_b16 v[42:43], v20 offset:39424
    v_lshlrev_b32 v14, 4, v12
    v_xor_b32 v14, v14, v6
    s_waitcnt lgkmcnt(4)
    v_mfma_f32_32x32x16_bf16 v[52:67], v[28:31], v[180:183], v[52:67]
    ds_read_b64_tr_b16 v[44:45], v20 offset:40960
    ds_read_b64_tr_b16 v[46:47], v20 offset:41472
    v_add_u32 v2, s48, v14
    v_lshlrev_b32 v13, 4, v13
    v_mfma_f32_32x32x16_bf16 v[52:67], v[32:35], v[184:187], v[52:67]
    ds_read_b64_tr_b16 v[48:49], v20 offset:43008
    ds_read_b64_tr_b16 v[50:51], v20 offset:43520
    v_lshl_add_u32 v18, v12, 11, v13
    v_mov_b32 v15, 142464
    s_waitcnt lgkmcnt(4)
    v_mfma_f32_32x32x16_bf16 v[52:67], v[36:39], v[188:191], v[52:67]
    ds_read_b64_tr_b16 v[28:29], v20 offset:45056
    ds_read_b64_tr_b16 v[30:31], v20 offset:45568
    v_mfma_f32_32x32x16_bf16 v[52:67], v[40:43], v[192:195], v[52:67]
    ds_read_b64_tr_b16 v[32:33], v20 offset:47104
    ds_read_b64_tr_b16 v[34:35], v20 offset:47616
    s_waitcnt lgkmcnt(4)
    v_mfma_f32_32x32x16_bf16 v[52:67], v[44:47], v[196:199], v[52:67]
    ds_read_b64_tr_b16 v[36:37], v20 offset:49152
    ds_read_b64_tr_b16 v[38:39], v20 offset:49664
    v_mfma_f32_32x32x16_bf16 v[52:67], v[48:51], v[200:203], v[52:67]
    ds_read_b64_tr_b16 v[40:41], v20 offset:51200
    ds_read_b64_tr_b16 v[42:43], v20 offset:51712
    s_waitcnt lgkmcnt(4)
    v_mfma_f32_32x32x16_bf16 v[52:67], v[28:31], v[204:207], v[52:67]
    ds_read_b64_tr_b16 v[44:45], v20 offset:53248
    ds_read_b64_tr_b16 v[46:47], v20 offset:53760
    v_mfma_f32_32x32x16_bf16 v[52:67], v[32:35], v[208:211], v[52:67]
    ds_read_b64_tr_b16 v[48:49], v20 offset:55296
    ds_read_b64_tr_b16 v[50:51], v20 offset:55808
    s_waitcnt lgkmcnt(4)
    v_mfma_f32_32x32x16_bf16 v[52:67], v[36:39], v[212:215], v[52:67]
    ds_read_b64_tr_b16 v[28:29], v20 offset:57344
    ds_read_b64_tr_b16 v[30:31], v20 offset:57856
    v_mfma_f32_32x32x16_bf16 v[52:67], v[40:43], v[216:219], v[52:67]
    ds_read_b64_tr_b16 v[32:33], v20 offset:59392
    ds_read_b64_tr_b16 v[34:35], v20 offset:59904
    s_waitcnt lgkmcnt(4)
    v_mfma_f32_32x32x16_bf16 v[52:67], v[44:47], v[220:223], v[52:67]
    ds_read_b64_tr_b16 v[36:37], v20 offset:61440
    ds_read_b64_tr_b16 v[38:39], v20 offset:61952
    v_mfma_f32_32x32x16_bf16 v[52:67], v[48:51], v[224:227], v[52:67]
    ds_read_b64_tr_b16 v[40:41], v20 offset:63488
    ds_read_b64_tr_b16 v[42:43], v20 offset:64000
    s_waitcnt lgkmcnt(4)
    v_mfma_f32_32x32x16_bf16 v[52:67], v[28:31], v[228:231], v[52:67]
    ds_read_b64_tr_b16 v[44:45], v21 offset:0
    ds_read_b64_tr_b16 v[46:47], v21 offset:512
    v_mfma_f32_32x32x16_bf16 v[52:67], v[32:35], v[232:235], v[52:67]
    ds_read_b64_tr_b16 v[48:49], v21 offset:2048
    ds_read_b64_tr_b16 v[50:51], v21 offset:2560
    s_waitcnt lgkmcnt(4)
    v_mfma_f32_32x32x16_bf16 v[52:67], v[36:39], v[236:239], v[52:67]
    ds_read_b64_tr_b16 v[28:29], v21 offset:4096
    ds_read_b64_tr_b16 v[30:31], v21 offset:4608
    v_mfma_f32_32x32x16_bf16 v[52:67], v[40:43], v[240:243], v[52:67]
    ds_read_b64_tr_b16 v[32:33], v21 offset:6144
    ds_read_b64_tr_b16 v[34:35], v21 offset:6656
    s_waitcnt lgkmcnt(4)
    v_mfma_f32_32x32x16_bf16 v[84:99], v[44:47], v[116:119], v[84:99]
    ds_read_b64_tr_b16 v[36:37], v21 offset:8192
    ds_read_b64_tr_b16 v[38:39], v21 offset:8704
    v_mfma_f32_32x32x16_bf16 v[84:99], v[48:51], v[120:123], v[84:99]
    ds_read_b64_tr_b16 v[40:41], v21 offset:10240
    ds_read_b64_tr_b16 v[42:43], v21 offset:10752
    s_waitcnt lgkmcnt(4)
    v_mfma_f32_32x32x16_bf16 v[84:99], v[28:31], v[124:127], v[84:99]
    ds_read_b64_tr_b16 v[44:45], v21 offset:12288
    ds_read_b64_tr_b16 v[46:47], v21 offset:12800
    v_mul_f32 v244, s0, v52
    v_mul_f32 v245, s0, v53
    v_mfma_f32_32x32x16_bf16 v[84:99], v[32:35], v[128:131], v[84:99]
    ds_read_b64_tr_b16 v[48:49], v21 offset:14336
    ds_read_b64_tr_b16 v[50:51], v21 offset:14848
    v_mul_f32 v246, s0, v54
    v_mul_f32 v247, s0, v55
    v_exp_f32_e64 v244, v244 clamp
    s_waitcnt lgkmcnt(4)
    v_mfma_f32_32x32x16_bf16 v[84:99], v[36:39], v[132:135], v[84:99]
    ds_read_b64_tr_b16 v[28:29], v21 offset:16384
    ds_read_b64_tr_b16 v[30:31], v21 offset:16896
    v_exp_f32_e64 v245, v245 clamp
    v_mfma_f32_32x32x16_bf16 v[84:99], v[40:43], v[136:139], v[84:99]
    ds_read_b64_tr_b16 v[32:33], v21 offset:18432
    ds_read_b64_tr_b16 v[34:35], v21 offset:18944
    v_exp_f32_e64 v246, v246 clamp
    v_exp_f32_e64 v247, v247 clamp
    s_waitcnt lgkmcnt(4)
    v_mfma_f32_32x32x16_bf16 v[84:99], v[44:47], v[140:143], v[84:99]
    ds_read_b64_tr_b16 v[36:37], v21 offset:20480
    ds_read_b64_tr_b16 v[38:39], v21 offset:20992
    v_max_f32 v52, s54, v52
    v_max_f32 v53, s54, v53
    v_mfma_f32_32x32x16_bf16 v[84:99], v[48:51], v[144:147], v[84:99]
    ds_read_b64_tr_b16 v[40:41], v21 offset:22528
    ds_read_b64_tr_b16 v[42:43], v21 offset:23040
    v_max_f32 v54, s54, v54
    v_max_f32 v55, s54, v55
    v_add_f32 v52, v52, v244
    s_waitcnt lgkmcnt(4)
    v_mfma_f32_32x32x16_bf16 v[84:99], v[28:31], v[148:151], v[84:99]
    ds_read_b64_tr_b16 v[44:45], v21 offset:24576
    ds_read_b64_tr_b16 v[46:47], v21 offset:25088
    v_add_f32 v53, v53, v245
    v_add_f32 v54, v54, v246
    v_mfma_f32_32x32x16_bf16 v[84:99], v[32:35], v[152:155], v[84:99]
    ds_read_b64_tr_b16 v[48:49], v21 offset:26624
    ds_read_b64_tr_b16 v[50:51], v21 offset:27136
    v_add_f32 v55, v55, v247
    v_cvt_pk_bf16_f32 v68, v52, v53
    v_cvt_pk_bf16_f32 v69, v54, v55
    s_waitcnt lgkmcnt(4)
    v_mfma_f32_32x32x16_bf16 v[84:99], v[36:39], v[156:159], v[84:99]
    ds_read_b64_tr_b16 v[28:29], v21 offset:28672
    ds_read_b64_tr_b16 v[30:31], v21 offset:29184
    v_mul_f32 v248, s0, v56
    v_mul_f32 v249, s0, v57
    v_mfma_f32_32x32x16_bf16 v[84:99], v[40:43], v[160:163], v[84:99]
    ds_read_b64_tr_b16 v[32:33], v21 offset:30720
    ds_read_b64_tr_b16 v[34:35], v21 offset:31232
    v_mul_f32 v250, s0, v58
    v_mul_f32 v251, s0, v59
    v_exp_f32_e64 v248, v248 clamp
    s_waitcnt lgkmcnt(4)
    v_mfma_f32_32x32x16_bf16 v[84:99], v[44:47], v[164:167], v[84:99]
    ds_read_b64_tr_b16 v[36:37], v21 offset:32768
    ds_read_b64_tr_b16 v[38:39], v21 offset:33280
    v_exp_f32_e64 v249, v249 clamp
    v_mfma_f32_32x32x16_bf16 v[84:99], v[48:51], v[168:171], v[84:99]
    ds_read_b64_tr_b16 v[40:41], v21 offset:34816
    ds_read_b64_tr_b16 v[42:43], v21 offset:35328
    v_exp_f32_e64 v250, v250 clamp
    v_exp_f32_e64 v251, v251 clamp
    s_waitcnt lgkmcnt(4)
    v_mfma_f32_32x32x16_bf16 v[84:99], v[28:31], v[172:175], v[84:99]
    ds_read_b64_tr_b16 v[44:45], v21 offset:36864
    ds_read_b64_tr_b16 v[46:47], v21 offset:37376
    v_max_f32 v56, s54, v56
    v_max_f32 v57, s54, v57
    v_mfma_f32_32x32x16_bf16 v[84:99], v[32:35], v[176:179], v[84:99]
    ds_read_b64_tr_b16 v[48:49], v21 offset:38912
    ds_read_b64_tr_b16 v[50:51], v21 offset:39424
    v_max_f32 v58, s54, v58
    v_max_f32 v59, s54, v59
    v_add_f32 v56, v56, v248
    s_waitcnt lgkmcnt(4)
    v_mfma_f32_32x32x16_bf16 v[84:99], v[36:39], v[180:183], v[84:99]
    ds_read_b64_tr_b16 v[28:29], v21 offset:40960
    ds_read_b64_tr_b16 v[30:31], v21 offset:41472
    v_add_f32 v57, v57, v249
    v_add_f32 v58, v58, v250
    v_mfma_f32_32x32x16_bf16 v[84:99], v[40:43], v[184:187], v[84:99]
    ds_read_b64_tr_b16 v[32:33], v21 offset:43008
    ds_read_b64_tr_b16 v[34:35], v21 offset:43520
    v_add_f32 v59, v59, v251
    v_cvt_pk_bf16_f32 v70, v56, v57
    v_cvt_pk_bf16_f32 v71, v58, v59
    s_waitcnt lgkmcnt(4)
    v_mfma_f32_32x32x16_bf16 v[84:99], v[44:47], v[188:191], v[84:99]
    ds_read_b64_tr_b16 v[36:37], v21 offset:45056
    ds_read_b64_tr_b16 v[38:39], v21 offset:45568
    v_mul_f32 v244, s0, v60
    v_mul_f32 v245, s0, v61
    v_mfma_f32_32x32x16_bf16 v[84:99], v[48:51], v[192:195], v[84:99]
    ds_read_b64_tr_b16 v[40:41], v21 offset:47104
    ds_read_b64_tr_b16 v[42:43], v21 offset:47616
    v_mul_f32 v246, s0, v62
    v_mul_f32 v247, s0, v63
    v_exp_f32_e64 v244, v244 clamp
    s_waitcnt lgkmcnt(4)
    v_mfma_f32_32x32x16_bf16 v[84:99], v[28:31], v[196:199], v[84:99]
    ds_read_b64_tr_b16 v[44:45], v21 offset:49152
    ds_read_b64_tr_b16 v[46:47], v21 offset:49664
    v_exp_f32_e64 v245, v245 clamp
    v_mfma_f32_32x32x16_bf16 v[84:99], v[32:35], v[200:203], v[84:99]
    ds_read_b64_tr_b16 v[48:49], v21 offset:51200
    ds_read_b64_tr_b16 v[50:51], v21 offset:51712
    v_exp_f32_e64 v246, v246 clamp
    v_exp_f32_e64 v247, v247 clamp
    s_waitcnt lgkmcnt(4)
    v_mfma_f32_32x32x16_bf16 v[84:99], v[36:39], v[204:207], v[84:99]
    ds_read_b64_tr_b16 v[28:29], v21 offset:53248
    ds_read_b64_tr_b16 v[30:31], v21 offset:53760
    v_max_f32 v60, s54, v60
    v_max_f32 v61, s54, v61
    v_mfma_f32_32x32x16_bf16 v[84:99], v[40:43], v[208:211], v[84:99]
    ds_read_b64_tr_b16 v[32:33], v21 offset:55296
    ds_read_b64_tr_b16 v[34:35], v21 offset:55808
    v_max_f32 v62, s54, v62
    v_max_f32 v63, s54, v63
    v_add_f32 v60, v60, v244
    s_waitcnt lgkmcnt(4)
    v_mfma_f32_32x32x16_bf16 v[84:99], v[44:47], v[212:215], v[84:99]
    ds_read_b64_tr_b16 v[36:37], v21 offset:57344
    ds_read_b64_tr_b16 v[38:39], v21 offset:57856
    v_add_f32 v61, v61, v245
    v_add_f32 v62, v62, v246
    v_mfma_f32_32x32x16_bf16 v[84:99], v[48:51], v[216:219], v[84:99]
    ds_read_b64_tr_b16 v[40:41], v21 offset:59392
    ds_read_b64_tr_b16 v[42:43], v21 offset:59904
    v_add_f32 v63, v63, v247
    v_cvt_pk_bf16_f32 v72, v60, v61
    v_cvt_pk_bf16_f32 v73, v62, v63
    s_waitcnt lgkmcnt(4)
    v_mfma_f32_32x32x16_bf16 v[84:99], v[28:31], v[220:223], v[84:99]
    ds_read_b64_tr_b16 v[44:45], v21 offset:61440
    ds_read_b64_tr_b16 v[46:47], v21 offset:61952
    v_mul_f32 v248, s0, v64
    v_mul_f32 v249, s0, v65
    v_mfma_f32_32x32x16_bf16 v[84:99], v[32:35], v[224:227], v[84:99]
    ds_read_b64_tr_b16 v[48:49], v21 offset:63488
    ds_read_b64_tr_b16 v[50:51], v21 offset:64000
    v_mul_f32 v250, s0, v66
    v_mul_f32 v251, s0, v67
    v_exp_f32_e64 v248, v248 clamp
    s_waitcnt lgkmcnt(4)
    v_mfma_f32_32x32x16_bf16 v[84:99], v[36:39], v[228:231], v[84:99]
    v_exp_f32_e64 v249, v249 clamp
    v_exp_f32_e64 v250, v250 clamp
    v_mfma_f32_32x32x16_bf16 v[84:99], v[40:43], v[232:235], v[84:99]
    v_exp_f32_e64 v251, v251 clamp
    v_max_f32 v64, s54, v64
    v_max_f32 v65, s54, v65
    v_max_f32 v66, s54, v66
    s_waitcnt lgkmcnt(0)
    v_mfma_f32_32x32x16_bf16 v[84:99], v[44:47], v[236:239], v[84:99]
    v_max_f32 v67, s54, v67
    v_add_f32 v64, v64, v248
    v_add_f32 v65, v65, v249
    v_add_f32 v66, v66, v250
    v_mfma_f32_32x32x16_bf16 v[84:99], v[48:51], v[240:243], v[84:99]
    v_add_f32 v67, v67, v251
    v_cvt_pk_bf16_f32 v74, v64, v65
    v_cvt_pk_bf16_f32 v75, v66, v67
    s_nop 8
    v_pk_mul_f32 v[244:245], v[84:85], s[0:1]
    v_pk_mul_f32 v[246:247], v[86:87], s[0:1]
    v_pk_mul_f32 v[248:249], v[88:89], s[0:1]
    v_pk_mul_f32 v[250:251], v[90:91], s[0:1]
    v_exp_f32_e64 v244, v244 clamp
    v_exp_f32_e64 v245, v245 clamp
    v_exp_f32_e64 v246, v246 clamp
    v_exp_f32_e64 v247, v247 clamp
    v_exp_f32_e64 v248, v248 clamp
    v_exp_f32_e64 v249, v249 clamp
    v_exp_f32_e64 v250, v250 clamp
    v_exp_f32_e64 v251, v251 clamp
    v_max_f32 v84, s54, v84
    v_max_f32 v85, s54, v85
    v_max_f32 v86, s54, v86
    v_max_f32 v87, s54, v87
    v_max_f32 v88, s54, v88
    v_max_f32 v89, s54, v89
    v_max_f32 v90, s54, v90
    v_max_f32 v91, s54, v91
    v_pk_add_f32 v[244:245], v[244:245], v[84:85]
    v_pk_add_f32 v[246:247], v[246:247], v[86:87]
    v_pk_add_f32 v[248:249], v[248:249], v[88:89]
    v_pk_add_f32 v[250:251], v[250:251], v[90:91]
    v_cvt_pk_bf16_f32 v76, v244, v245
    v_cvt_pk_bf16_f32 v77, v246, v247
    v_cvt_pk_bf16_f32 v78, v248, v249
    v_cvt_pk_bf16_f32 v79, v250, v251
    v_pk_mul_f32 v[244:245], v[92:93], s[0:1]
    v_pk_mul_f32 v[246:247], v[94:95], s[0:1]
    v_pk_mul_f32 v[248:249], v[96:97], s[0:1]
    v_pk_mul_f32 v[250:251], v[98:99], s[0:1]
    v_exp_f32_e64 v244, v244 clamp
    v_exp_f32_e64 v245, v245 clamp
    v_exp_f32_e64 v246, v246 clamp
    v_exp_f32_e64 v247, v247 clamp
    v_exp_f32_e64 v248, v248 clamp
    v_exp_f32_e64 v249, v249 clamp
    v_exp_f32_e64 v250, v250 clamp
    v_exp_f32_e64 v251, v251 clamp
    v_max_f32 v92, s54, v92
    v_max_f32 v93, s54, v93
    v_max_f32 v94, s54, v94
    v_max_f32 v95, s54, v95
    v_max_f32 v96, s54, v96
    v_max_f32 v97, s54, v97
    v_max_f32 v98, s54, v98
    v_max_f32 v99, s54, v99
    v_pk_add_f32 v[244:245], v[244:245], v[92:93]
    v_pk_add_f32 v[246:247], v[246:247], v[94:95]
    v_pk_add_f32 v[248:249], v[248:249], v[96:97]
    v_pk_add_f32 v[250:251], v[250:251], v[98:99]
    v_cvt_pk_bf16_f32 v80, v244, v245
    v_cvt_pk_bf16_f32 v81, v246, v247
    v_cvt_pk_bf16_f32 v82, v248, v249
    v_cvt_pk_bf16_f32 v83, v250, v251
    s_barrier
    ds_read_b128 v[36:39], v4
    ds_read_b128 v[40:43], v5
    ds_read_b128 v[44:47], v24
    ds_read_b128 v[48:51], v25
    ds_read_b32 v15, v15
    s_waitcnt lgkmcnt(4)
    v_mfma_f32_32x32x16_bf16 v[196:211], v[36:39], v[68:71], 0
    s_waitcnt lgkmcnt(3)
    v_mfma_f32_32x32x16_bf16 v[212:227], v[40:43], v[72:75], 0
    s_waitcnt lgkmcnt(2)
    v_mfma_f32_32x32x16_bf16 v[228:243], v[44:47], v[76:79], 0
    s_waitcnt lgkmcnt(1)
    v_mfma_f32_32x32x16_bf16 v[100:115], v[48:51], v[80:83], 0
    s_waitcnt lgkmcnt(0)
    v_readfirstlane_b32 s52, v15
    s_nop 3
    v_add_f32 v204, s54, v204
    v_rcp_f32 v204, v204
    v_add_f32 v212, s54, v212
    v_rcp_f32 v212, v212
    v_pk_mul_f32 v[196:197], v[196:197], v[204:205] op_sel_hi:[1,0]
    v_pk_mul_f32 v[198:199], v[198:199], v[204:205] op_sel_hi:[1,0]
    v_pk_mul_f32 v[200:201], v[200:201], v[204:205] op_sel_hi:[1,0]
    v_pk_mul_f32 v[202:203], v[202:203], v[204:205] op_sel_hi:[1,0]
    v_cvt_pk_bf16_f32 v116, v196, v197
    v_cvt_pk_bf16_f32 v117, v198, v199
    v_cvt_pk_bf16_f32 v118, v200, v201
    v_cvt_pk_bf16_f32 v119, v202, v203
    v_bfi_b32 v116, s60, v8, v116
    v_bitop3_b32 v117, s60, v9, v117 bitop3:0x3a
    v_bfi_b32 v118, s60, v10, v118
    v_bitop3_b32 v119, s60, v11, v119 bitop3:0x3a
    s_cmp_eq_u32 s52, 0
    s_cbranch_scc0 B_far0
    buffer_store_dwordx4 v[116:119], v6, s[40:43], s44 offen offset:0
B_sto0:
    v_add_f32 v236, s54, v236
    v_rcp_f32 v236, v236
    v_pk_mul_f32 v[220:221], v[220:221], v[212:213] op_sel_hi:[1,0]
    v_pk_mul_f32 v[222:223], v[222:223], v[212:213] op_sel_hi:[1,0]
    v_pk_mul_f32 v[224:225], v[224:225], v[212:213] op_sel_hi:[1,0]
    v_pk_mul_f32 v[226:227], v[226:227], v[212:213] op_sel_hi:[1,0]
    v_cvt_pk_bf16_f32 v120, v220, v221
    v_cvt_pk_bf16_f32 v121, v222, v223
    v_cvt_pk_bf16_f32 v122, v224, v225
    v_cvt_pk_bf16_f32 v123, v226, v227
    v_bfi_b32 v120, s60, v8, v120
    v_bitop3_b32 v121, s60, v9, v121 bitop3:0x3a
    v_bfi_b32 v122, s60, v10, v122
    v_bitop3_b32 v123, s60, v11, v123 bitop3:0x3a
    s_cbranch_scc0 B_far1
    buffer_store_dwordx4 v[120:123], v6, s[40:43], s44 offen offset:1024
B_sto1:
    v_add_f32 v100, s54, v100
    v_rcp_f32 v100, v100
    v_pk_mul_f32 v[228:229], v[228:229], v[236:237] op_sel_hi:[1,0]
    v_pk_mul_f32 v[230:231], v[230:231], v[236:237] op_sel_hi:[1,0]
    v_pk_mul_f32 v[232:233], v[232:233], v[236:237] op_sel_hi:[1,0]
    v_pk_mul_f32 v[234:235], v[234:235], v[236:237] op_sel_hi:[1,0]
    v_cvt_pk_bf16_f32 v124, v228, v229
    v_cvt_pk_bf16_f32 v125, v230, v231
    v_cvt_pk_bf16_f32 v126, v232, v233
    v_cvt_pk_bf16_f32 v127, v234, v235
    v_bfi_b32 v124, s60, v8, v124
    v_bitop3_b32 v125, s60, v9, v125 bitop3:0x3a
    v_bfi_b32 v126, s60, v10, v126
    v_bitop3_b32 v127, s60, v11, v127 bitop3:0x3a
    s_cbranch_scc0 B_far2
    buffer_store_dwordx4 v[124:127], v6, s[40:43], s44 offen offset:2048
B_sto2:
    v_pk_mul_f32 v[108:109], v[108:109], v[100:101] op_sel_hi:[1,0]
    v_pk_mul_f32 v[110:111], v[110:111], v[100:101] op_sel_hi:[1,0]
    v_pk_mul_f32 v[112:113], v[112:113], v[100:101] op_sel_hi:[1,0]
    v_pk_mul_f32 v[114:115], v[114:115], v[100:101] op_sel_hi:[1,0]
    v_cvt_pk_bf16_f32 v128, v108, v109
    v_cvt_pk_bf16_f32 v129, v110, v111
    v_cvt_pk_bf16_f32 v130, v112, v113
    v_cvt_pk_bf16_f32 v131, v114, v115
    v_bfi_b32 v128, s60, v8, v128
    v_bitop3_b32 v129, s60, v9, v129 bitop3:0x3a
    v_bfi_b32 v130, s60, v10, v130
    v_bitop3_b32 v131, s60, v11, v131 bitop3:0x3a
    s_cbranch_scc0 B_far3
    buffer_store_dwordx4 v[128:131], v6, s[40:43], s44 offen offset:3072
B_sto3:
    s_lshl_b32 s49, s64, 1
    v_add_u32 v16, s49, v26
    v_xor_b32 v17, 64, v16
    s_mov_b32 s61, 100000
    s_cmp_eq_u32 s52, 0
    s_cbranch_scc0 B_probe
B_probed:
    ds_read_b64_tr_b16 v[36:37], v16 offset:0
    ds_read_b64_tr_b16 v[38:39], v16 offset:1024
    ds_read_b64_tr_b16 v[40:41], v17 offset:0
    ds_read_b64_tr_b16 v[42:43], v17 offset:1024
    ds_read_b64_tr_b16 v[44:45], v16 offset:2048
    ds_read_b64_tr_b16 v[46:47], v16 offset:3072
    ds_read_b64_tr_b16 v[48:49], v17 offset:2048
    ds_read_b64_tr_b16 v[50:51], v17 offset:3072
    s_add_u32 s48, s65, s18
    buffer_load_dwordx4 v[132:135], v6, s[40:43], s48 offen offset:0 sc1
    buffer_load_dwordx4 v[136:139], v6, s[40:43], s48 offen offset:1024 sc1
    buffer_load_dwordx4 v[140:143], v6, s[40:43], s48 offen offset:2048 sc1
    buffer_load_dwordx4 v[144:147], v6, s[40:43], s48 offen offset:3072 sc1
    s_add_u32 s48, s66, s18
    buffer_load_dwordx4 v[148:151], v6, s[40:43], s48 offen offset:0 sc1
    buffer_load_dwordx4 v[152:155], v6, s[40:43], s48 offen offset:1024 sc1
    buffer_load_dwordx4 v[156:159], v6, s[40:43], s48 offen offset:2048 sc1
    buffer_load_dwordx4 v[160:163], v6, s[40:43], s48 offen offset:3072 sc1
    v_xor_b32 v116, v116, v8
    v_xor_b32 v117, v117, v9
    v_xor_b32 v118, v118, v10
    v_xor_b32 v119, v119, v11
    s_waitcnt lgkmcnt(4)
    s_nop 0
    v_mfma_f32_32x32x16_bf16 v[52:67], v[36:39], v[116:119], 0
    ds_read_b64_tr_b16 v[28:29], v16 offset:4096
    ds_read_b64_tr_b16 v[30:31], v16 offset:5120
    v_mfma_f32_32x32x16_bf16 v[84:99], v[40:43], v[116:119], 0
    ds_read_b64_tr_b16 v[32:33], v17 offset:4096
    ds_read_b64_tr_b16 v[34:35], v17 offset:5120
    s_add_u32 s48, s67, s18
    buffer_load_dwordx4 v[164:167], v6, s[40:43], s48 offen offset:0 sc1
    buffer_load_dwordx4 v[168:171], v6, s[40:43], s48 offen offset:1024 sc1
    buffer_load_dwordx4 v[172:175], v6, s[40:43], s48 offen offset:2048 sc1
    buffer_load_dwordx4 v[176:179], v6, s[40:43], s48 offen offset:3072 sc1
    v_xor_b32 v120, v120, v8
    v_xor_b32 v121, v121, v9
    v_xor_b32 v122, v122, v10
    v_xor_b32 v123, v123, v11
    s_waitcnt lgkmcnt(4)
    s_nop 0
    v_mfma_f32_32x32x16_bf16 v[52:67], v[44:47], v[120:123], v[52:67]
    ds_read_b64_tr_b16 v[36:37], v16 offset:6144
    ds_read_b64_tr_b16 v[38:39], v16 offset:7168
    v_mfma_f32_32x32x16_bf16 v[84:99], v[48:51], v[120:123], v[84:99]
    s_lshl_b32 s49, s65, 1
    v_add_u32 v20, s49, v26
    v_xor_b32 v21, 64, v20
    ds_read_b64_tr_b16 v[40:41], v17 offset:6144
    ds_read_b64_tr_b16 v[42:43], v17 offset:7168
    v_xor_b32 v124, v124, v8
    v_xor_b32 v125, v125, v9
    v_xor_b32 v126, v126, v10
    v_xor_b32 v127, v127, v11
    s_waitcnt lgkmcnt(4)
    s_nop 0
    v_mfma_f32_32x32x16_bf16 v[52:67], v[28:31], v[124:127], v[52:67]
    ds_read_b64_tr_b16 v[44:45], v20 offset:0
    ds_read_b64_tr_b16 v[46:47], v20 offset:1024
    v_mfma_f32_32x32x16_bf16 v[84:99], v[32:35], v[124:127], v[84:99]
    ds_read_b64_tr_b16 v[48:49], v21 offset:0
    ds_read_b64_tr_b16 v[50:51], v21 offset:1024
    v_xor_b32 v128, v128, v8
    v_xor_b32 v129, v129, v9
    v_xor_b32 v130, v130, v10
    v_xor_b32 v131, v131, v11
    s_waitcnt lgkmcnt(4)
    s_nop 0
    v_mfma_f32_32x32x16_bf16 v[52:67], v[36:39], v[128:131], v[52:67]
    ds_read_b64_tr_b16 v[28:29], v20 offset:2048
    ds_read_b64_tr_b16 v[30:31], v20 offset:3072
    v_mfma_f32_32x32x16_bf16 v[84:99], v[40:43], v[128:131], v[84:99]
    ds_read_b64_tr_b16 v[32:33], v21 offset:2048
    ds_read_b64_tr_b16 v[34:35], v21 offset:3072
    s_waitcnt vmcnt(8)
    v_xor_b32 v132, v132, v8
    v_xor_b32 v133, v133, v9
    v_xor_b32 v134, v134, v10
    v_xor_b32 v135, v135, v11
    v_bitop3_b32 v19, v132, v132, v133 bitop3:0xfd
    v_bitop3_b32 v19, v19, v134, v135 bitop3:0xfd
    v_xor_b32 v136, v136, v8
    v_xor_b32 v137, v137, v9
    v_xor_b32 v138, v138, v10
    v_xor_b32 v139, v139, v11
    v_bitop3_b32 v19, v19, v136, v137 bitop3:0xfd
    v_bitop3_b32 v19, v19, v138, v139 bitop3:0xfd
    v_xor_b32 v140, v140, v8
    v_xor_b32 v141, v141, v9
    v_xor_b32 v142, v142, v10
    v_xor_b32 v143, v143, v11
    v_bitop3_b32 v19, v19, v140, v141 bitop3:0xfd
    v_bitop3_b32 v19, v19, v142, v143 bitop3:0xfd
    v_xor_b32 v144, v144, v8
    v_xor_b32 v145, v145, v9
    v_xor_b32 v146, v146, v10
    v_xor_b32 v147, v147, v11
    v_bitop3_b32 v19, v19, v144, v145 bitop3:0xfd
    v_bitop3_b32 v19, v19, v146, v147 bitop3:0xfd
    v_and_b32 v19, s60, v19
    v_cmp_ne_u32 vcc, 0, v19
    s_cbranch_vccnz B_retry1
B_ok1:
    s_waitcnt lgkmcnt(4)
    v_mfma_f32_32x32x16_bf16 v[52:67], v[44:47], v[132:135], v[52:67]
    ds_read_b64_tr_b16 v[36:37], v20 offset:4096
    ds_read_b64_tr_b16 v[38:39], v20 offset:5120
    v_mfma_f32_32x32x16_bf16 v[84:99], v[48:51], v[132:135], v[84:99]
    ds_read_b64_tr_b16 v[40:41], v21 offset:4096
    ds_read_b64_tr_b16 v[42:43], v21 offset:5120
    s_waitcnt vmcnt(4)
    v_xor_b32 v148, v148, v8
    v_xor_b32 v149, v149, v9
    v_xor_b32 v150, v150, v10
    v_xor_b32 v151, v151, v11
    s_waitcnt lgkmcnt(4)
    v_mfma_f32_32x32x16_bf16 v[52:67], v[28:31], v[136:139], v[52:67]
    ds_read_b64_tr_b16 v[44:45], v20 offset:6144
    ds_read_b64_tr_b16 v[46:47], v20 offset:7168
    v_bitop3_b32 v19, v148, v148, v149 bitop3:0xfd
    v_bitop3_b32 v19, v19, v150, v151 bitop3:0xfd
    v_xor_b32 v152, v152, v8
    v_xor_b32 v153, v153, v9
    v_mfma_f32_32x32x16_bf16 v[84:99], v[32:35], v[136:139], v[84:99]
    s_lshl_b32 s49, s66, 1
    v_add_u32 v16, s49, v26
    v_xor_b32 v17, 64, v16
    ds_read_b64_tr_b16 v[48:49], v21 offset:6144
    ds_read_b64_tr_b16 v[50:51], v21 offset:7168
    v_xor_b32 v154, v154, v10
    v_xor_b32 v155, v155, v11
    v_bitop3_b32 v19, v19, v152, v153 bitop3:0xfd
    v_bitop3_b32 v19, v19, v154, v155 bitop3:0xfd
    s_waitcnt lgkmcnt(4)
    v_mfma_f32_32x32x16_bf16 v[52:67], v[36:39], v[140:143], v[52:67]
    ds_read_b64_tr_b16 v[28:29], v16 offset:0
    ds_read_b64_tr_b16 v[30:31], v16 offset:1024
    v_xor_b32 v156, v156, v8
    v_xor_b32 v157, v157, v9
    v_xor_b32 v158, v158, v10
    v_xor_b32 v159, v159, v11
    v_mfma_f32_32x32x16_bf16 v[84:99], v[40:43], v[140:143], v[84:99]
    ds_read_b64_tr_b16 v[32:33], v17 offset:0
    ds_read_b64_tr_b16 v[34:35], v17 offset:1024
    v_bitop3_b32 v19, v19, v156, v157 bitop3:0xfd
    v_bitop3_b32 v19, v19, v158, v159 bitop3:0xfd
    v_xor_b32 v160, v160, v8
    v_xor_b32 v161, v161, v9
    s_waitcnt lgkmcnt(4)
    v_mfma_f32_32x32x16_bf16 v[52:67], v[44:47], v[144:147], v[52:67]
    ds_read_b64_tr_b16 v[36:37], v16 offset:2048
    ds_read_b64_tr_b16 v[38:39], v16 offset:3072
    v_xor_b32 v162, v162, v10
    v_xor_b32 v163, v163, v11
    v_bitop3_b32 v19, v19, v160, v161 bitop3:0xfd
    v_mfma_f32_32x32x16_bf16 v[84:99], v[48:51], v[144:147], v[84:99]
    ds_read_b64_tr_b16 v[40:41], v17 offset:2048
    ds_read_b64_tr_b16 v[42:43], v17 offset:3072
    v_bitop3_b32 v19, v19, v162, v163 bitop3:0xfd
    v_and_b32 v19, s60, v19
    v_cmp_ne_u32 vcc, 0, v19
    s_cbranch_vccnz B_retry2
B_ok2:
    s_add_u32 s48, s68, s18
    buffer_load_dwordx4 v[180:183], v6, s[40:43], s48 offen offset:0 sc1
    buffer_load_dwordx4 v[184:187], v6, s[40:43], s48 offen offset:1024 sc1
    buffer_load_dwordx4 v[188:191], v6, s[40:43], s48 offen offset:2048 sc1
    buffer_load_dwordx4 v[192:195], v6, s[40:43], s48 offen offset:3072 sc1
    s_waitcnt lgkmcnt(4)
    v_mfma_f32_32x32x16_bf16 v[52:67], v[28:31], v[148:151], v[52:67]
    ds_read_b64_tr_b16 v[44:45], v16 offset:4096
    ds_read_b64_tr_b16 v[46:47], v16 offset:5120
    v_mfma_f32_32x32x16_bf16 v[84:99], v[32:35], v[148:151], v[84:99]
    ds_read_b64_tr_b16 v[48:49], v17 offset:4096
    ds_read_b64_tr_b16 v[50:51], v17 offset:5120
    s_waitcnt vmcnt(4)
    v_xor_b32 v164, v164, v8
    v_xor_b32 v165, v165, v9
    v_xor_b32 v166, v166, v10
    v_xor_b32 v167, v167, v11
    s_waitcnt lgkmcnt(4)
    v_mfma_f32_32x32x16_bf16 v[52:67], v[36:39], v[152:155], v[52:67]
    ds_read_b64_tr_b16 v[28:29], v16 offset:6144
    ds_read_b64_tr_b16 v[30:31], v16 offset:7168
    v_bitop3_b32 v19, v164, v164, v165 bitop3:0xfd
    v_bitop3_b32 v19, v19, v166, v167 bitop3:0xfd
    v_xor_b32 v168, v168, v8
    v_xor_b32 v169, v169, v9
    v_mfma_f32_32x32x16_bf16 v[84:99], v[40:43], v[152:155], v[84:99]
    s_lshl_b32 s49, s67, 1
    v_add_u32 v20, s49, v26
    v_xor_b32 v21, 64, v20
    ds_read_b64_tr_b16 v[32:33], v17 offset:6144
    ds_read_b64_tr_b16 v[34:35], v17 offset:7168
    v_xor_b32 v170, v170, v10
    v_xor_b32 v171, v171, v11
    v_bitop3_b32 v19, v19, v168, v169 bitop3:0xfd
    v_bitop3_b32 v19, v19, v170, v171 bitop3:0xfd
    s_waitcnt lgkmcnt(4)
    v_mfma_f32_32x32x16_bf16 v[52:67], v[44:47], v[156:159], v[52:67]
    ds_read_b64_tr_b16 v[36:37], v20 offset:0
    ds_read_b64_tr_b16 v[38:39], v20 offset:1024
    v_xor_b32 v172, v172, v8
    v_xor_b32 v173, v173, v9
    v_xor_b32 v174, v174, v10
    v_xor_b32 v175, v175, v11
    v_mfma_f32_32x32x16_bf16 v[84:99], v[48:51], v[156:159], v[84:99]
    ds_read_b64_tr_b16 v[40:41], v21 offset:0
    ds_read_b64_tr_b16 v[42:43], v21 offset:1024
    v_bitop3_b32 v19, v19, v172, v173 bitop3:0xfd
    v_bitop3_b32 v19, v19, v174, v175 bitop3:0xfd
    v_xor_b32 v176, v176, v8
    v_xor_b32 v177, v177, v9
    s_waitcnt lgkmcnt(4)
    v_mfma_f32_32x32x16_bf16 v[52:67], v[28:31], v[160:163], v[52:67]
    ds_read_b64_tr_b16 v[44:45], v20 offset:2048
    ds_read_b64_tr_b16 v[46:47], v20 offset:3072
    v_xor_b32 v178, v178, v10
    v_xor_b32 v179, v179, v11
    v_bitop3_b32 v19, v19, v176, v177 bitop3:0xfd
    v_mfma_f32_32x32x16_bf16 v[84:99], v[32:35], v[160:163], v[84:99]
    ds_read_b64_tr_b16 v[48:49], v21 offset:2048
    ds_read_b64_tr_b16 v[50:51], v21 offset:3072
    v_bitop3_b32 v19, v19, v178, v179 bitop3:0xfd
    v_and_b32 v19, s60, v19
    v_cmp_ne_u32 vcc, 0, v19
    s_cbranch_vccnz B_retry3
B_ok3:
    s_add_u32 s48, s69, s18
    buffer_load_dwordx4 v[196:199], v6, s[40:43], s48 offen offset:0 sc1
    buffer_load_dwordx4 v[200:203], v6, s[40:43], s48 offen offset:1024 sc1
    buffer_load_dwordx4 v[204:207], v6, s[40:43], s48 offen offset:2048 sc1
    buffer_load_dwordx4 v[208:211], v6, s[40:43], s48 offen offset:3072 sc1
    s_waitcnt lgkmcnt(4)
    v_mfma_f32_32x32x16_bf16 v[52:67], v[36:39], v[164:167], v[52:67]
    ds_read_b64_tr_b16 v[28:29], v20 offset:4096
    ds_read_b64_tr_b16 v[30:31], v20 offset:5120
    v_mfma_f32_32x32x16_bf16 v[84:99], v[40:43], v[164:167], v[84:99]
    ds_read_b64_tr_b16 v[32:33], v21 offset:4096
    ds_read_b64_tr_b16 v[34:35], v21 offset:5120
    s_waitcnt vmcnt(4)
    v_xor_b32 v180, v180, v8
    v_xor_b32 v181, v181, v9
    v_xor_b32 v182, v182, v10
    v_xor_b32 v183, v183, v11
    s_waitcnt lgkmcnt(4)
    v_mfma_f32_32x32x16_bf16 v[52:67], v[44:47], v[168:171], v[52:67]
    ds_read_b64_tr_b16 v[36:37], v20 offset:6144
    ds_read_b64_tr_b16 v[38:39], v20 offset:7168
    v_bitop3_b32 v19, v180, v180, v181 bitop3:0xfd
    v_bitop3_b32 v19, v19, v182, v183 bitop3:0xfd
    v_xor_b32 v184, v184, v8
    v_xor_b32 v185, v185, v9
    v_mfma_f32_32x32x16_bf16 v[84:99], v[48:51], v[168:171], v[84:99]
    s_lshl_b32 s49, s68, 1
    v_add_u32 v16, s49, v26
    v_xor_b32 v17, 64, v16
    ds_read_b64_tr_b16 v[40:41], v21 offset:6144
    ds_read_b64_tr_b16 v[42:43], v21 offset:7168
    v_xor_b32 v186, v186, v10
    v_xor_b32 v187, v187, v11
    v_bitop3_b32 v19, v19, v184, v185 bitop3:0xfd
    v_bitop3_b32 v19, v19, v186, v187 bitop3:0xfd
    s_waitcnt lgkmcnt(4)
    v_mfma_f32_32x32x16_bf16 v[52:67], v[28:31], v[172:175], v[52:67]
    ds_read_b64_tr_b16 v[44:45], v16 offset:0
    ds_read_b64_tr_b16 v[46:47], v16 offset:1024
    v_xor_b32 v188, v188, v8
    v_xor_b32 v189, v189, v9
    v_xor_b32 v190, v190, v10
    v_xor_b32 v191, v191, v11
    v_mfma_f32_32x32x16_bf16 v[84:99], v[32:35], v[172:175], v[84:99]
    ds_read_b64_tr_b16 v[48:49], v17 offset:0
    ds_read_b64_tr_b16 v[50:51], v17 offset:1024
    v_bitop3_b32 v19, v19, v188, v189 bitop3:0xfd
    v_bitop3_b32 v19, v19, v190, v191 bitop3:0xfd
    v_xor_b32 v192, v192, v8
    v_xor_b32 v193, v193, v9
    s_waitcnt lgkmcnt(4)
    v_mfma_f32_32x32x16_bf16 v[52:67], v[36:39], v[176:179], v[52:67]
    ds_read_b64_tr_b16 v[28:29], v16 offset:2048
    ds_read_b64_tr_b16 v[30:31], v16 offset:3072
    v_xor_b32 v194, v194, v10
    v_xor_b32 v195, v195, v11
    v_bitop3_b32 v19, v19, v192, v193 bitop3:0xfd
    v_mfma_f32_32x32x16_bf16 v[84:99], v[40:43], v[176:179], v[84:99]
    ds_read_b64_tr_b16 v[32:33], v17 offset:2048
    ds_read_b64_tr_b16 v[34:35], v17 offset:3072
    v_bitop3_b32 v19, v19, v194, v195 bitop3:0xfd
    v_and_b32 v19, s60, v19
    v_cmp_ne_u32 vcc, 0, v19
    s_cbranch_vccnz B_retry4
B_ok4:
    s_add_u32 s48, s70, s18
    buffer_load_dwordx4 v[212:215], v6, s[40:43], s48 offen offset:0 sc1
    buffer_load_dwordx4 v[216:219], v6, s[40:43], s48 offen offset:1024 sc1
    buffer_load_dwordx4 v[220:223], v6, s[40:43], s48 offen offset:2048 sc1
    buffer_load_dwordx4 v[224:227], v6, s[40:43], s48 offen offset:3072 sc1
    s_waitcnt lgkmcnt(4)
    v_mfma_f32_32x32x16_bf16 v[52:67], v[44:47], v[180:183], v[52:67]
    ds_read_b64_tr_b16 v[36:37], v16 offset:4096
    ds_read_b64_tr_b16 v[38:39], v16 offset:5120
    v_mfma_f32_32x32x16_bf16 v[84:99], v[48:51], v[180:183], v[84:99]
    ds_read_b64_tr_b16 v[40:41], v17 offset:4096
    ds_read_b64_tr_b16 v[42:43], v17 offset:5120
    s_waitcnt vmcnt(4)
    v_xor_b32 v196, v196, v8
    v_xor_b32 v197, v197, v9
    v_xor_b32 v198, v198, v10
    v_xor_b32 v199, v199, v11
    s_waitcnt lgkmcnt(4)
    v_mfma_f32_32x32x16_bf16 v[52:67], v[28:31], v[184:187], v[52:67]
    ds_read_b64_tr_b16 v[44:45], v16 offset:6144
    ds_read_b64_tr_b16 v[46:47], v16 offset:7168
    v_bitop3_b32 v19, v196, v196, v197 bitop3:0xfd
    v_bitop3_b32 v19, v19, v198, v199 bitop3:0xfd
    v_xor_b32 v200, v200, v8
    v_xor_b32 v201, v201, v9
    v_mfma_f32_32x32x16_bf16 v[84:99], v[32:35], v[184:187], v[84:99]
    s_lshl_b32 s49, s69, 1
    v_add_u32 v20, s49, v26
    v_xor_b32 v21, 64, v20
    ds_read_b64_tr_b16 v[48:49], v17 offset:6144
    ds_read_b64_tr_b16 v[50:51], v17 offset:7168
    v_xor_b32 v202, v202, v10
    v_xor_b32 v203, v203, v11
    v_bitop3_b32 v19, v19, v200, v201 bitop3:0xfd
    v_bitop3_b32 v19, v19, v202, v203 bitop3:0xfd
    s_waitcnt lgkmcnt(4)
    v_mfma_f32_32x32x16_bf16 v[52:67], v[36:39], v[188:191], v[52:67]
    ds_read_b64_tr_b16 v[28:29], v20 offset:0
    ds_read_b64_tr_b16 v[30:31], v20 offset:1024
    v_xor_b32 v204, v204, v8
    v_xor_b32 v205, v205, v9
    v_xor_b32 v206, v206, v10
    v_xor_b32 v207, v207, v11
    v_mfma_f32_32x32x16_bf16 v[84:99], v[40:43], v[188:191], v[84:99]
    ds_read_b64_tr_b16 v[32:33], v21 offset:0
    ds_read_b64_tr_b16 v[34:35], v21 offset:1024
    v_bitop3_b32 v19, v19, v204, v205 bitop3:0xfd
    v_bitop3_b32 v19, v19, v206, v207 bitop3:0xfd
    v_xor_b32 v208, v208, v8
    v_xor_b32 v209, v209, v9
    s_waitcnt lgkmcnt(4)
    v_mfma_f32_32x32x16_bf16 v[52:67], v[44:47], v[192:195], v[52:67]
    ds_read_b64_tr_b16 v[36:37], v20 offset:2048
    ds_read_b64_tr_b16 v[38:39], v20 offset:3072
    v_xor_b32 v210, v210, v10
    v_xor_b32 v211, v211, v11
    v_bitop3_b32 v19, v19, v208, v209 bitop3:0xfd
    v_mfma_f32_32x32x16_bf16 v[84:99], v[48:51], v[192:195], v[84:99]
    ds_read_b64_tr_b16 v[40:41], v21 offset:2048
    ds_read_b64_tr_b16 v[42:43], v21 offset:3072
    v_bitop3_b32 v19, v19, v210, v211 bitop3:0xfd
    v_and_b32 v19, s60, v19
    v_cmp_ne_u32 vcc, 0, v19
    s_cbranch_vccnz B_retry5
B_ok5:
    s_add_u32 s48, s71, s18
    buffer_load_dwordx4 v[228:231], v6, s[40:43], s48 offen offset:0 sc1
    buffer_load_dwordx4 v[232:235], v6, s[40:43], s48 offen offset:1024 sc1
    buffer_load_dwordx4 v[236:239], v6, s[40:43], s48 offen offset:2048 sc1
    buffer_load_dwordx4 v[240:243], v6, s[40:43], s48 offen offset:3072 sc1
    s_waitcnt lgkmcnt(4)
    v_mfma_f32_32x32x16_bf16 v[52:67], v[28:31], v[196:199], v[52:67]
    ds_read_b64_tr_b16 v[44:45], v20 offset:4096
    ds_read_b64_tr_b16 v[46:47], v20 offset:5120
    v_mfma_f32_32x32x16_bf16 v[84:99], v[32:35], v[196:199], v[84:99]
    ds_read_b64_tr_b16 v[48:49], v21 offset:4096
    ds_read_b64_tr_b16 v[50:51], v21 offset:5120
    s_waitcnt vmcnt(4)
    v_xor_b32 v212, v212, v8
    v_xor_b32 v213, v213, v9
    v_xor_b32 v214, v214, v10
    v_xor_b32 v215, v215, v11
    s_waitcnt lgkmcnt(4)
    v_mfma_f32_32x32x16_bf16 v[52:67], v[36:39], v[200:203], v[52:67]
    ds_read_b64_tr_b16 v[28:29], v20 offset:6144
    ds_read_b64_tr_b16 v[30:31], v20 offset:7168
    v_bitop3_b32 v19, v212, v212, v213 bitop3:0xfd
    v_bitop3_b32 v19, v19, v214, v215 bitop3:0xfd
    v_xor_b32 v216, v216, v8
    v_xor_b32 v217, v217, v9
    v_mfma_f32_32x32x16_bf16 v[84:99], v[40:43], v[200:203], v[84:99]
    s_lshl_b32 s49, s70, 1
    v_add_u32 v16, s49, v26
    v_xor_b32 v17, 64, v16
    ds_read_b64_tr_b16 v[32:33], v21 offset:6144
    ds_read_b64_tr_b16 v[34:35], v21 offset:7168
    v_xor_b32 v218, v218, v10
    v_xor_b32 v219, v219, v11
    v_bitop3_b32 v19, v19, v216, v217 bitop3:0xfd
    v_bitop3_b32 v19, v19, v218, v219 bitop3:0xfd
    s_waitcnt lgkmcnt(4)
    v_mfma_f32_32x32x16_bf16 v[52:67], v[44:47], v[204:207], v[52:67]
    ds_read_b64_tr_b16 v[36:37], v16 offset:0
    ds_read_b64_tr_b16 v[38:39], v16 offset:1024
    v_xor_b32 v220, v220, v8
    v_xor_b32 v221, v221, v9
    v_xor_b32 v222, v222, v10
    v_xor_b32 v223, v223, v11
    v_mfma_f32_32x32x16_bf16 v[84:99], v[48:51], v[204:207], v[84:99]
    ds_read_b64_tr_b16 v[40:41], v17 offset:0
    ds_read_b64_tr_b16 v[42:43], v17 offset:1024
    v_bitop3_b32 v19, v19, v220, v221 bitop3:0xfd
    v_bitop3_b32 v19, v19, v222, v223 bitop3:0xfd
    v_xor_b32 v224, v224, v8
    v_xor_b32 v225, v225, v9
    s_waitcnt lgkmcnt(4)
    v_mfma_f32_32x32x16_bf16 v[52:67], v[28:31], v[208:211], v[52:67]
    ds_read_b64_tr_b16 v[44:45], v16 offset:2048
    ds_read_b64_tr_b16 v[46:47], v16 offset:3072
    v_xor_b32 v226, v226, v10
    v_xor_b32 v227, v227, v11
    v_bitop3_b32 v19, v19, v224, v225 bitop3:0xfd
    v_mfma_f32_32x32x16_bf16 v[84:99], v[32:35], v[208:211], v[84:99]
    ds_read_b64_tr_b16 v[48:49], v17 offset:2048
    ds_read_b64_tr_b16 v[50:51], v17 offset:3072
    v_bitop3_b32 v19, v19, v226, v227 bitop3:0xfd
    v_and_b32 v19, s60, v19
    v_cmp_ne_u32 vcc, 0, v19
    s_cbranch_vccnz B_retry6
B_ok6:
    s_waitcnt lgkmcnt(4)
    v_mfma_f32_32x32x16_bf16 v[52:67], v[36:39], v[212:215], v[52:67]
    ds_read_b64_tr_b16 v[28:29], v16 offset:4096
    ds_read_b64_tr_b16 v[30:31], v16 offset:5120
    v_mfma_f32_32x32x16_bf16 v[84:99], v[40:43], v[212:215], v[84:99]
    ds_read_b64_tr_b16 v[32:33], v17 offset:4096
    ds_read_b64_tr_b16 v[34:35], v17 offset:5120
    s_waitcnt vmcnt(0)
    v_xor_b32 v228, v228, v8
    v_xor_b32 v229, v229, v9
    v_xor_b32 v230, v230, v10
    v_xor_b32 v231, v231, v11
    s_waitcnt lgkmcnt(4)
    v_mfma_f32_32x32x16_bf16 v[52:67], v[44:47], v[216:219], v[52:67]
    ds_read_b64_tr_b16 v[36:37], v16 offset:6144
    ds_read_b64_tr_b16 v[38:39], v16 offset:7168
    v_bitop3_b32 v19, v228, v228, v229 bitop3:0xfd
    v_bitop3_b32 v19, v19, v230, v231 bitop3:0xfd
    v_xor_b32 v232, v232, v8
    v_xor_b32 v233, v233, v9
    v_mfma_f32_32x32x16_bf16 v[84:99], v[48:51], v[216:219], v[84:99]
    s_lshl_b32 s49, s71, 1
    v_add_u32 v20, s49, v26
    v_xor_b32 v21, 64, v20
    ds_read_b64_tr_b16 v[40:41], v17 offset:6144
    ds_read_b64_tr_b16 v[42:43], v17 offset:7168
    v_xor_b32 v234, v234, v10
    v_xor_b32 v235, v235, v11
    v_bitop3_b32 v19, v19, v232, v233 bitop3:0xfd
    v_bitop3_b32 v19, v19, v234, v235 bitop3:0xfd
    s_waitcnt lgkmcnt(4)
    v_mfma_f32_32x32x16_bf16 v[52:67], v[28:31], v[220:223], v[52:67]
    ds_read_b64_tr_b16 v[44:45], v20 offset:0
    ds_read_b64_tr_b16 v[46:47], v20 offset:1024
    v_xor_b32 v236, v236, v8
    v_xor_b32 v237, v237, v9
    v_xor_b32 v238, v238, v10
    v_xor_b32 v239, v239, v11
    v_mfma_f32_32x32x16_bf16 v[84:99], v[32:35], v[220:223], v[84:99]
    ds_read_b64_tr_b16 v[48:49], v20 offset:2048
    ds_read_b64_tr_b16 v[50:51], v20 offset:3072
    v_bitop3_b32 v19, v19, v236, v237 bitop3:0xfd
    v_bitop3_b32 v19, v19, v238, v239 bitop3:0xfd
    v_xor_b32 v240, v240, v8
    v_xor_b32 v241, v241, v9
    s_waitcnt lgkmcnt(4)
    v_mfma_f32_32x32x16_bf16 v[52:67], v[36:39], v[224:227], v[52:67]
    ds_read_b64_tr_b16 v[28:29], v20 offset:4096
    ds_read_b64_tr_b16 v[30:31], v20 offset:5120
    v_xor_b32 v242, v242, v10
    v_xor_b32 v243, v243, v11
    v_bitop3_b32 v19, v19, v240, v241 bitop3:0xfd
    v_mfma_f32_32x32x16_bf16 v[84:99], v[40:43], v[224:227], v[84:99]
    ds_read_b64_tr_b16 v[32:33], v20 offset:6144
    ds_read_b64_tr_b16 v[34:35], v20 offset:7168
    v_bitop3_b32 v19, v19, v242, v243 bitop3:0xfd
    v_and_b32 v19, s60, v19
    v_cmp_ne_u32 vcc, 0, v19
    s_cbranch_vccnz B_retry7
B_ok7:
    s_waitcnt lgkmcnt(4)
    v_mfma_f32_32x32x16_bf16 v[52:67], v[44:47], v[228:231], v[52:67]
    ds_read_b64_tr_b16 v[36:37], v21 offset:0
    ds_read_b64_tr_b16 v[38:39], v21 offset:1024
    v_mfma_f32_32x32x16_bf16 v[52:67], v[48:51], v[232:235], v[52:67]
    ds_read_b64_tr_b16 v[40:41], v21 offset:2048
    ds_read_b64_tr_b16 v[42:43], v21 offset:3072
    s_waitcnt lgkmcnt(4)
    v_mfma_f32_32x32x16_bf16 v[52:67], v[28:31], v[236:239], v[52:67]
    ds_read_b64_tr_b16 v[44:45], v21 offset:4096
    ds_read_b64_tr_b16 v[46:47], v21 offset:5120
    v_mfma_f32_32x32x16_bf16 v[52:67], v[32:35], v[240:243], v[52:67]
    ds_read_b64_tr_b16 v[48:49], v21 offset:6144
    ds_read_b64_tr_b16 v[50:51], v21 offset:7168
    s_waitcnt lgkmcnt(4)
    v_mfma_f32_32x32x16_bf16 v[84:99], v[36:39], v[228:231], v[84:99]
    v_mfma_f32_32x32x16_bf16 v[84:99], v[40:43], v[232:235], v[84:99]
    s_nop 6
    v_cvt_pk_bf16_f32 v116, v52, v53
    v_cvt_pk_bf16_f32 v117, v54, v55
    v_cvt_pk_bf16_f32 v118, v56, v57
    v_cvt_pk_bf16_f32 v119, v58, v59
    ds_write_b64 v22, v[116:117]
    v_xor_b32 v22, 16, v22
    s_waitcnt lgkmcnt(0)
    v_mfma_f32_32x32x16_bf16 v[84:99], v[44:47], v[236:239], v[84:99]
    ds_write_b64 v22, v[118:119]
    v_cvt_pk_bf16_f32 v120, v60, v61
    v_cvt_pk_bf16_f32 v121, v62, v63
    v_cvt_pk_bf16_f32 v122, v64, v65
    v_cvt_pk_bf16_f32 v123, v66, v67
    v_mfma_f32_32x32x16_bf16 v[84:99], v[48:51], v[240:243], v[84:99]
    ds_write_b64 v23, v[120:121]
    v_xor_b32 v23, 16, v23
    ds_write_b64 v23, v[122:123]
    s_or_b32 s48, s2, s3
    s_cmp_lg_u32 s48, 8
    s_cbranch_scc1 B_nononce
    v_mov_b32 v12, s22
    v_mov_b32 v13, 0
    buffer_store_dword v12, v13, s[40:43], 0 offen offset:256
B_nononce:
    s_nop 5
    v_cvt_pk_bf16_f32 v124, v84, v85
    v_cvt_pk_bf16_f32 v125, v86, v87
    v_cvt_pk_bf16_f32 v126, v88, v89
    v_cvt_pk_bf16_f32 v127, v90, v91
    ds_write_b64 v27, v[124:125]
    v_xor_b32 v27, 16, v27
    ds_write_b64 v27, v[126:127]
    v_cvt_pk_bf16_f32 v128, v92, v93
    v_cvt_pk_bf16_f32 v129, v94, v95
    v_cvt_pk_bf16_f32 v130, v96, v97
    v_cvt_pk_bf16_f32 v131, v98, v99
    ds_write_b64 v1, v[128:129]
    v_xor_b32 v1, 16, v1
    ds_write_b64 v1, v[130:131]
    s_waitcnt lgkmcnt(0)
    ds_read_b128 v[132:135], v2 offset:0
    ds_read_b128 v[136:139], v2 offset:1024
    ds_read_b128 v[140:143], v2 offset:2048
    ds_read_b128 v[144:147], v2 offset:3072
    s_waitcnt lgkmcnt(3)
    buffer_store_dwordx4 v[132:135], v18, s[36:39], s19 offen
    s_add_u32 s19, s19, 16384
    s_waitcnt lgkmcnt(2)
    buffer_store_dwordx4 v[136:139], v18, s[36:39], s19 offen
    s_add_u32 s19, s19, 16384
    s_waitcnt lgkmcnt(1)
    buffer_store_dwordx4 v[140:143], v18, s[36:39], s19 offen
    s_add_u32 s19, s19, 16384
    s_waitcnt lgkmcnt(0)
    buffer_store_dwordx4 v[144:147], v18, s[36:39], s19 offen
    s_endpgm
B_far0:
    buffer_store_dwordx4 v[116:119], v6, s[40:43], s44 offen offset:0 sc1
    s_branch B_sto0
B_far1:
    buffer_store_dwordx4 v[120:123], v6, s[40:43], s44 offen offset:1024 sc1
    s_branch B_sto1
B_far2:
    buffer_store_dwordx4 v[124:127], v6, s[40:43], s44 offen offset:2048 sc1
    s_branch B_sto2
B_far3:
    buffer_store_dwordx4 v[128:131], v6, s[40:43], s44 offen offset:3072 sc1
    s_branch B_sto3
B_probe:
    v_bfe_u32 v13, v0, 2, 3
    v_lshlrev_b32 v13, 12, v13
    v_lshl_add_u32 v13, v3, 4, v13
    s_waitcnt vmcnt(0)
B_probe1:
    s_cmp_eq_u32 s61, 0
    s_cbranch_scc1 B_probed
    s_sub_u32 s61, s61, 1
    buffer_load_dwordx4 v[244:247], v13, s[40:43], s18 offen offset:3072 sc1
    s_waitcnt vmcnt(0)
    v_xor_b32 v244, v244, v8
    v_xor_b32 v245, v245, v9
    v_xor_b32 v246, v246, v10
    v_xor_b32 v247, v247, v11
    v_bitop3_b32 v19, v244, v244, v245 bitop3:0xfd
    v_bitop3_b32 v19, v19, v246, v247 bitop3:0xfd
    v_and_b32 v19, s60, v19
    v_cmp_ne_u32 vcc, 0, v19
    s_cbranch_vccnz B_probe1
    s_branch B_probed
B_retry1:
    s_cmp_eq_u32 s61, 0
    s_cbranch_scc1 B_ok1
    s_sub_u32 s61, s61, 1
    s_add_u32 s48, s65, s18
    buffer_load_dwordx4 v[132:135], v6, s[40:43], s48 offen offset:0 sc1
    buffer_load_dwordx4 v[136:139], v6, s[40:43], s48 offen offset:1024 sc1
    buffer_load_dwordx4 v[140:143], v6, s[40:43], s48 offen offset:2048 sc1
    buffer_load_dwordx4 v[144:147], v6, s[40:43], s48 offen offset:3072 sc1
    s_waitcnt vmcnt(0)
    v_xor_b32 v132, v132, v8
    v_xor_b32 v133, v133, v9
    v_xor_b32 v134, v134, v10
    v_xor_b32 v135, v135, v11
    v_bitop3_b32 v19, v132, v132, v133 bitop3:0xfd
    v_bitop3_b32 v19, v19, v134, v135 bitop3:0xfd
    v_xor_b32 v136, v136, v8
    v_xor_b32 v137, v137, v9
    v_xor_b32 v138, v138, v10
    v_xor_b32 v139, v139, v11
    v_bitop3_b32 v19, v19, v136, v137 bitop3:0xfd
    v_bitop3_b32 v19, v19, v138, v139 bitop3:0xfd
    v_xor_b32 v140, v140, v8
    v_xor_b32 v141, v141, v9
    v_xor_b32 v142, v142, v10
    v_xor_b32 v143, v143, v11
    v_bitop3_b32 v19, v19, v140, v141 bitop3:0xfd
    v_bitop3_b32 v19, v19, v142, v143 bitop3:0xfd
    v_xor_b32 v144, v144, v8
    v_xor_b32 v145, v145, v9
    v_xor_b32 v146, v146, v10
    v_xor_b32 v147, v147, v11
    v_bitop3_b32 v19, v19, v144, v145 bitop3:0xfd
    v_bitop3_b32 v19, v19, v146, v147 bitop3:0xfd
    v_and_b32 v19, s60, v19
    v_cmp_ne_u32 vcc, 0, v19
    s_cbranch_vccnz B_retry1
    s_branch B_ok1
B_retry2:
    s_cmp_eq_u32 s61, 0
    s_cbranch_scc1 B_ok2
    s_sub_u32 s61, s61, 1
    s_add_u32 s48, s66, s18
    buffer_load_dwordx4 v[148:151], v6, s[40:43], s48 offen offset:0 sc1
    buffer_load_dwordx4 v[152:155], v6, s[40:43], s48 offen offset:1024 sc1
    buffer_load_dwordx4 v[156:159], v6, s[40:43], s48 offen offset:2048 sc1
    buffer_load_dwordx4 v[160:163], v6, s[40:43], s48 offen offset:3072 sc1
    s_waitcnt vmcnt(0)
    v_xor_b32 v148, v148, v8
    v_xor_b32 v149, v149, v9
    v_xor_b32 v150, v150, v10
    v_xor_b32 v151, v151, v11
    v_bitop3_b32 v19, v148, v148, v149 bitop3:0xfd
    v_bitop3_b32 v19, v19, v150, v151 bitop3:0xfd
    v_xor_b32 v152, v152, v8
    v_xor_b32 v153, v153, v9
    v_xor_b32 v154, v154, v10
    v_xor_b32 v155, v155, v11
    v_bitop3_b32 v19, v19, v152, v153 bitop3:0xfd
    v_bitop3_b32 v19, v19, v154, v155 bitop3:0xfd
    v_xor_b32 v156, v156, v8
    v_xor_b32 v157, v157, v9
    v_xor_b32 v158, v158, v10
    v_xor_b32 v159, v159, v11
    v_bitop3_b32 v19, v19, v156, v157 bitop3:0xfd
    v_bitop3_b32 v19, v19, v158, v159 bitop3:0xfd
    v_xor_b32 v160, v160, v8
    v_xor_b32 v161, v161, v9
    v_xor_b32 v162, v162, v10
    v_xor_b32 v163, v163, v11
    v_bitop3_b32 v19, v19, v160, v161 bitop3:0xfd
    v_bitop3_b32 v19, v19, v162, v163 bitop3:0xfd
    v_and_b32 v19, s60, v19
    v_cmp_ne_u32 vcc, 0, v19
    s_cbranch_vccnz B_retry2
    s_branch B_ok2
B_retry3:
    s_cmp_eq_u32 s61, 0
    s_cbranch_scc1 B_ok3
    s_sub_u32 s61, s61, 1
    s_add_u32 s48, s67, s18
    buffer_load_dwordx4 v[164:167], v6, s[40:43], s48 offen offset:0 sc1
    buffer_load_dwordx4 v[168:171], v6, s[40:43], s48 offen offset:1024 sc1
    buffer_load_dwordx4 v[172:175], v6, s[40:43], s48 offen offset:2048 sc1
    buffer_load_dwordx4 v[176:179], v6, s[40:43], s48 offen offset:3072 sc1
    s_waitcnt vmcnt(0)
    v_xor_b32 v164, v164, v8
    v_xor_b32 v165, v165, v9
    v_xor_b32 v166, v166, v10
    v_xor_b32 v167, v167, v11
    v_bitop3_b32 v19, v164, v164, v165 bitop3:0xfd
    v_bitop3_b32 v19, v19, v166, v167 bitop3:0xfd
    v_xor_b32 v168, v168, v8
    v_xor_b32 v169, v169, v9
    v_xor_b32 v170, v170, v10
    v_xor_b32 v171, v171, v11
    v_bitop3_b32 v19, v19, v168, v169 bitop3:0xfd
    v_bitop3_b32 v19, v19, v170, v171 bitop3:0xfd
    v_xor_b32 v172, v172, v8
    v_xor_b32 v173, v173, v9
    v_xor_b32 v174, v174, v10
    v_xor_b32 v175, v175, v11
    v_bitop3_b32 v19, v19, v172, v173 bitop3:0xfd
    v_bitop3_b32 v19, v19, v174, v175 bitop3:0xfd
    v_xor_b32 v176, v176, v8
    v_xor_b32 v177, v177, v9
    v_xor_b32 v178, v178, v10
    v_xor_b32 v179, v179, v11
    v_bitop3_b32 v19, v19, v176, v177 bitop3:0xfd
    v_bitop3_b32 v19, v19, v178, v179 bitop3:0xfd
    v_and_b32 v19, s60, v19
    v_cmp_ne_u32 vcc, 0, v19
    s_cbranch_vccnz B_retry3
    s_branch B_ok3
B_retry4:
    s_cmp_eq_u32 s61, 0
    s_cbranch_scc1 B_ok4
    s_sub_u32 s61, s61, 1
    s_add_u32 s48, s68, s18
    buffer_load_dwordx4 v[180:183], v6, s[40:43], s48 offen offset:0 sc1
    buffer_load_dwordx4 v[184:187], v6, s[40:43], s48 offen offset:1024 sc1
    buffer_load_dwordx4 v[188:191], v6, s[40:43], s48 offen offset:2048 sc1
    buffer_load_dwordx4 v[192:195], v6, s[40:43], s48 offen offset:3072 sc1
    s_waitcnt vmcnt(0)
    v_xor_b32 v180, v180, v8
    v_xor_b32 v181, v181, v9
    v_xor_b32 v182, v182, v10
    v_xor_b32 v183, v183, v11
    v_bitop3_b32 v19, v180, v180, v181 bitop3:0xfd
    v_bitop3_b32 v19, v19, v182, v183 bitop3:0xfd
    v_xor_b32 v184, v184, v8
    v_xor_b32 v185, v185, v9
    v_xor_b32 v186, v186, v10
    v_xor_b32 v187, v187, v11
    v_bitop3_b32 v19, v19, v184, v185 bitop3:0xfd
    v_bitop3_b32 v19, v19, v186, v187 bitop3:0xfd
    v_xor_b32 v188, v188, v8
    v_xor_b32 v189, v189, v9
    v_xor_b32 v190, v190, v10
    v_xor_b32 v191, v191, v11
    v_bitop3_b32 v19, v19, v188, v189 bitop3:0xfd
    v_bitop3_b32 v19, v19, v190, v191 bitop3:0xfd
    v_xor_b32 v192, v192, v8
    v_xor_b32 v193, v193, v9
    v_xor_b32 v194, v194, v10
    v_xor_b32 v195, v195, v11
    v_bitop3_b32 v19, v19, v192, v193 bitop3:0xfd
    v_bitop3_b32 v19, v19, v194, v195 bitop3:0xfd
    v_and_b32 v19, s60, v19
    v_cmp_ne_u32 vcc, 0, v19
    s_cbranch_vccnz B_retry4
    s_branch B_ok4
B_retry5:
    s_cmp_eq_u32 s61, 0
    s_cbranch_scc1 B_ok5
    s_sub_u32 s61, s61, 1
    s_add_u32 s48, s69, s18
    buffer_load_dwordx4 v[196:199], v6, s[40:43], s48 offen offset:0 sc1
    buffer_load_dwordx4 v[200:203], v6, s[40:43], s48 offen offset:1024 sc1
    buffer_load_dwordx4 v[204:207], v6, s[40:43], s48 offen offset:2048 sc1
    buffer_load_dwordx4 v[208:211], v6, s[40:43], s48 offen offset:3072 sc1
    s_waitcnt vmcnt(0)
    v_xor_b32 v196, v196, v8
    v_xor_b32 v197, v197, v9
    v_xor_b32 v198, v198, v10
    v_xor_b32 v199, v199, v11
    v_bitop3_b32 v19, v196, v196, v197 bitop3:0xfd
    v_bitop3_b32 v19, v19, v198, v199 bitop3:0xfd
    v_xor_b32 v200, v200, v8
    v_xor_b32 v201, v201, v9
    v_xor_b32 v202, v202, v10
    v_xor_b32 v203, v203, v11
    v_bitop3_b32 v19, v19, v200, v201 bitop3:0xfd
    v_bitop3_b32 v19, v19, v202, v203 bitop3:0xfd
    v_xor_b32 v204, v204, v8
    v_xor_b32 v205, v205, v9
    v_xor_b32 v206, v206, v10
    v_xor_b32 v207, v207, v11
    v_bitop3_b32 v19, v19, v204, v205 bitop3:0xfd
    v_bitop3_b32 v19, v19, v206, v207 bitop3:0xfd
    v_xor_b32 v208, v208, v8
    v_xor_b32 v209, v209, v9
    v_xor_b32 v210, v210, v10
    v_xor_b32 v211, v211, v11
    v_bitop3_b32 v19, v19, v208, v209 bitop3:0xfd
    v_bitop3_b32 v19, v19, v210, v211 bitop3:0xfd
    v_and_b32 v19, s60, v19
    v_cmp_ne_u32 vcc, 0, v19
    s_cbranch_vccnz B_retry5
    s_branch B_ok5
B_retry6:
    s_cmp_eq_u32 s61, 0
    s_cbranch_scc1 B_ok6
    s_sub_u32 s61, s61, 1
    s_add_u32 s48, s70, s18
    buffer_load_dwordx4 v[212:215], v6, s[40:43], s48 offen offset:0 sc1
    buffer_load_dwordx4 v[216:219], v6, s[40:43], s48 offen offset:1024 sc1
    buffer_load_dwordx4 v[220:223], v6, s[40:43], s48 offen offset:2048 sc1
    buffer_load_dwordx4 v[224:227], v6, s[40:43], s48 offen offset:3072 sc1
    s_waitcnt vmcnt(0)
    v_xor_b32 v212, v212, v8
    v_xor_b32 v213, v213, v9
    v_xor_b32 v214, v214, v10
    v_xor_b32 v215, v215, v11
    v_bitop3_b32 v19, v212, v212, v213 bitop3:0xfd
    v_bitop3_b32 v19, v19, v214, v215 bitop3:0xfd
    v_xor_b32 v216, v216, v8
    v_xor_b32 v217, v217, v9
    v_xor_b32 v218, v218, v10
    v_xor_b32 v219, v219, v11
    v_bitop3_b32 v19, v19, v216, v217 bitop3:0xfd
    v_bitop3_b32 v19, v19, v218, v219 bitop3:0xfd
    v_xor_b32 v220, v220, v8
    v_xor_b32 v221, v221, v9
    v_xor_b32 v222, v222, v10
    v_xor_b32 v223, v223, v11
    v_bitop3_b32 v19, v19, v220, v221 bitop3:0xfd
    v_bitop3_b32 v19, v19, v222, v223 bitop3:0xfd
    v_xor_b32 v224, v224, v8
    v_xor_b32 v225, v225, v9
    v_xor_b32 v226, v226, v10
    v_xor_b32 v227, v227, v11
    v_bitop3_b32 v19, v19, v224, v225 bitop3:0xfd
    v_bitop3_b32 v19, v19, v226, v227 bitop3:0xfd
    v_and_b32 v19, s60, v19
    v_cmp_ne_u32 vcc, 0, v19
    s_cbranch_vccnz B_retry6
    s_branch B_ok6
B_retry7:
    s_cmp_eq_u32 s61, 0
    s_cbranch_scc1 B_ok7
    s_sub_u32 s61, s61, 1
    s_add_u32 s48, s71, s18
    buffer_load_dwordx4 v[228:231], v6, s[40:43], s48 offen offset:0 sc1
    buffer_load_dwordx4 v[232:235], v6, s[40:43], s48 offen offset:1024 sc1
    buffer_load_dwordx4 v[236:239], v6, s[40:43], s48 offen offset:2048 sc1
    buffer_load_dwordx4 v[240:243], v6, s[40:43], s48 offen offset:3072 sc1
    s_waitcnt vmcnt(0)
    v_xor_b32 v228, v228, v8
    v_xor_b32 v229, v229, v9
    v_xor_b32 v230, v230, v10
    v_xor_b32 v231, v231, v11
    v_bitop3_b32 v19, v228, v228, v229 bitop3:0xfd
    v_bitop3_b32 v19, v19, v230, v231 bitop3:0xfd
    v_xor_b32 v232, v232, v8
    v_xor_b32 v233, v233, v9
    v_xor_b32 v234, v234, v10
    v_xor_b32 v235, v235, v11
    v_bitop3_b32 v19, v19, v232, v233 bitop3:0xfd
    v_bitop3_b32 v19, v19, v234, v235 bitop3:0xfd
    v_xor_b32 v236, v236, v8
    v_xor_b32 v237, v237, v9
    v_xor_b32 v238, v238, v10
    v_xor_b32 v239, v239, v11
    v_bitop3_b32 v19, v19, v236, v237 bitop3:0xfd
    v_bitop3_b32 v19, v19, v238, v239 bitop3:0xfd
    v_xor_b32 v240, v240, v8
    v_xor_b32 v241, v241, v9
    v_xor_b32 v242, v242, v10
    v_xor_b32 v243, v243, v11
    v_bitop3_b32 v19, v19, v240, v241 bitop3:0xfd
    v_bitop3_b32 v19, v19, v242, v243 bitop3:0xfd
    v_and_b32 v19, s60, v19
    v_cmp_ne_u32 vcc, 0, v19
    s_cbranch_vccnz B_retry7
    s_branch B_ok7
L_A:
    s_lshr_b32 s44, s2, 4
    s_lshl_b32 s44, s44, 3
    s_and_b32 s45, s2, 7
    s_or_b32 s23, s44, s45
    s_lshl_b32 s44, s3, 8
    s_add_u32 s44, s44, s23
    s_lshl_b32 s44, s44, 10
    s_add_u32 s45, s44, 130048
    s_lshl_b32 m0, s3, 11
    s_waitcnt lgkmcnt(0)
    s_mov_b32 s24, s4
    s_mov_b32 s25, s5
    s_mov_b32 s26, 0x200000
    s_mov_b32 s27, 0x20000
    s_load_dword s22, s[20:21], 0
    s_mov_b64 s[0:1], s[44:45]
    s_mov_b32 s28, s12
    s_mov_b32 s29, s13
    s_mov_b32 s30, 0x180000
    s_mov_b32 s31, 0x20000
    s_sub_u32 s47, 384, s12
    s_and_b32 s47, s47, 0x380
    s_lshr_b32 s46, s47, 7
    s_add_u32 s46, s46, s23
    s_bfe_u32 s48, s23, 0x10005
    s_add_u32 s46, s46, s48
    s_bfe_u32 s48, s23, 0x10006
    s_lshl_b32 s48, s48, 2
    s_add_u32 s46, s46, s48
    s_add_u32 s46, s46, 2
    s_and_b32 s46, s46, 7
    s_lshl_b32 s46, s46, 5
    s_and_b32 s48, s23, 24
    s_add_u32 s48, s48, s3
    s_add_u32 s48, s48, s46
    s_mul_i32 s48, s48, 6144
    s_add_u32 s48, s48, s47
    s_add_u32 s48, s48, 1024
    v_lshrrev_b32 v12, 1, v0
    v_mul_u32_u24 v12, 3072, v12
    v_and_b32 v14, 1, v0
    v_lshl_add_u32 v12, v14, 10, v12
    s_mov_b64 exec, 15
    buffer_load_dword v253, v12, s[28:31], s48 offen
    s_mov_b64 exec, -1
    s_and_b32 s46, s23, 7
    s_sub_u32 s47, 16, s46
    s_cmp_eq_u32 s46, 0
    s_cselect_b32 s47, 8, s47
    s_bitcmp1_b32 s23, 6
    s_cselect_b32 s46, s47, s46
    s_and_b32 s47, s23, 24
    s_add_u32 s47, s47, s3
    s_lshl_b32 s47, s47, 6
    s_add_u32 s46, s46, s47
    s_mul_i32 s46, s46, 514
    s_add_u32 s46, s46, 512
    s_bitcmp1_b32 s23, 5
    s_cselect_b32 s32, s8, s6
    s_cselect_b32 s33, s9, s7
    s_mov_b32 s34, 1052672
    s_mov_b32 s35, 0x20000
    v_mul_u32_u24 v12, 8224, v0
    s_mov_b64 exec, 15
    buffer_load_dword v252, v12, s[32:35], s46 offen
    s_mov_b64 exec, -1
    s_mov_b32 s36, s16
    s_mov_b32 s37, s17
    s_mov_b32 s38, 0x400000
    s_mov_b32 s39, 0x20000
    s_mov_b32 s40, s20
    s_mov_b32 s41, s21
    s_mov_b32 s42, 0x700000
    s_mov_b32 s43, 0x20000
    s_mov_b32 s54, 0x00010001
    s_mov_b32 s55, 0x00010001
    v_cvt_f32_u32 v34, v1
    v_lshlrev_b32 v12, 2, v2
    v_cvt_f32_u32 v38, v12
    v_add_f32 v39, 1.0, v38
    v_add_f32 v40, 2.0, v38
    v_add_f32 v41, 2.0, v39
    v_mul_f32 v35, 0x3d000000, v34
    v_mul_f32 v46, v38, v35
    v_mul_f32 v47, v39, v35
    v_mul_f32 v48, v40, v35
    v_mul_f32 v49, v41, v35
    v_cos_f32 v42, v46
    v_cos_f32 v43, v47
    v_cos_f32 v44, v48
    v_cos_f32 v45, v49
    v_sin_f32 v46, v46
    v_sin_f32 v47, v47
    v_sin_f32 v48, v48
    v_sin_f32 v49, v49
    v_and_b32 v12, 1, v1
    v_mul_u32_u24 v12, 0x8000, v12
    v_lshl_or_b32 v12, v12, 16, v12
    v_cvt_pk_bf16_f32 v50, v42, v43
    v_cvt_pk_bf16_f32 v51, v44, v45
    v_cvt_pk_bf16_f32 v54, -v46, -v47
    v_cvt_pk_bf16_f32 v55, -v48, -v49
    v_xor_b32 v52, v50, v12
    v_xor_b32 v56, v54, v12
    v_xor_b32 v53, v51, v12
    v_xor_b32 v57, v55, v12
    s_mov_b64 exec, s[54:55]
    v_mov_b32 v54, 0xbf803f80
    v_mov_b32 v55, 0xbf803f80
    v_mov_b32 v56, 0xbf803f80
    v_mov_b32 v57, 0xbf803f80
    s_mov_b64 exec, -1
    v_mul_f32 v35, 0xbb000000, v34
    v_mul_f32 v62, v38, v35
    v_mul_f32 v63, v39, v35
    v_mul_f32 v64, v40, v35
    v_mul_f32 v65, v41, v35
    v_cos_f32 v58, v62
    v_cos_f32 v59, v63
    v_cos_f32 v60, v64
    v_cos_f32 v61, v65
    v_sin_f32 v62, v62
    v_sin_f32 v63, v63
    v_sin_f32 v64, v64
    v_sin_f32 v65, v65
    v_cmp_gt_u32 vcc, 8, v1
    v_sub_f32 v12, 0x41b80000, v34
    s_nop 0
    v_cndmask_b32 v12, v12, v34, vcc
    v_mul_f32 v35, 0x3d800000, v12
    v_mov_b32 v13, 0x80008000
    v_cndmask_b32_e64 v13, v13, 0, vcc
    v_add_f32 v14, v34, v34
    v_add_f32 v15, 0xc1700000, v14
    v_cndmask_b32 v14, v15, v14, vcc
    v_mul_f32 v36, 0x3d000000, v14
    v_cndmask_b32_e64 v14, 16, 0, vcc
    v_mul_f32 v46, v38, v35
    v_mul_f32 v47, v39, v35
    v_mul_f32 v48, v40, v35
    v_mul_f32 v49, v41, v35
    v_cos_f32 v42, v46
    v_cos_f32 v43, v47
    v_cos_f32 v44, v48
    v_cos_f32 v45, v49
    v_sin_f32 v46, v46
    v_sin_f32 v47, v47
    v_sin_f32 v48, v48
    v_sin_f32 v49, v49
    v_cvt_pk_bf16_f32 v66, v42, v46
    v_cvt_pk_bf16_f32 v70, -v46, v42
    v_cvt_pk_bf16_f32 v67, v43, v47
    v_cvt_pk_bf16_f32 v71, -v47, v43
    v_cvt_pk_bf16_f32 v68, v44, v48
    v_cvt_pk_bf16_f32 v72, -v48, v44
    v_cvt_pk_bf16_f32 v69, v45, v49
    v_cvt_pk_bf16_f32 v73, -v49, v45
    v_xor_b32 v70, v70, v13
    v_xor_b32 v71, v71, v13
    v_xor_b32 v72, v72, v13
    v_xor_b32 v73, v73, v13
    v_mul_f32 v46, v38, v36
    v_mul_f32 v47, v39, v36
    v_mul_f32 v48, v40, v36
    v_mul_f32 v49, v41, v36
    v_cos_f32 v42, v46
    v_cos_f32 v43, v47
    v_cos_f32 v44, v48
    v_cos_f32 v45, v49
    v_sin_f32 v46, v46
    v_sin_f32 v47, v47
    v_sin_f32 v48, v48
    v_sin_f32 v49, v49
    s_mov_b64 exec, s[54:55]
    v_mov_b32 v46, -1.0
    v_mov_b32 v47, 1.0
    v_mov_b32 v48, -1.0
    v_mov_b32 v49, 1.0
    s_mov_b64 exec, -1
    v_cvt_pk_bf16_f32 v74, v42, 0
    v_cvt_pk_bf16_f32 v78, -v46, 0
    v_cvt_pk_bf16_f32 v75, v43, 0
    v_cvt_pk_bf16_f32 v79, -v47, 0
    v_cvt_pk_bf16_f32 v76, v44, 0
    v_cvt_pk_bf16_f32 v80, -v48, 0
    v_cvt_pk_bf16_f32 v77, v45, 0
    v_cvt_pk_bf16_f32 v81, -v49, 0
    v_lshlrev_b32 v74, v14, v74
    v_lshlrev_b32 v78, v14, v78
    v_lshlrev_b32 v75, v14, v75
    v_lshlrev_b32 v79, v14, v79
    v_lshlrev_b32 v76, v14, v76
    v_lshlrev_b32 v80, v14, v80
    v_lshlrev_b32 v77, v14, v77
    v_lshlrev_b32 v81, v14, v81
    v_cvt_f32_u32 v90, s23
    v_mul_f32 v90, 0x3a000000, v90
    v_mul_f32 v35, 0x3d800000, v34
    v_mul_f32 v36, v90, v34
    v_fma_f32 v46, v38, v35, v36
    v_fma_f32 v47, v39, v35, v36
    v_fma_f32 v48, v40, v35, v36
    v_fma_f32 v49, v41, v35, v36
    v_cos_f32 v42, v46
    v_cos_f32 v43, v47
    v_cos_f32 v44, v48
    v_cos_f32 v45, v49
    v_sin_f32 v46, v46
    v_sin_f32 v47, v47
    v_sin_f32 v48, v48
    v_sin_f32 v49, v49
    v_cvt_pk_bf16_f32 v82, v42, v46
    v_cvt_pk_bf16_f32 v86, -v46, v42
    v_cvt_pk_bf16_f32 v83, v43, v47
    v_cvt_pk_bf16_f32 v87, -v47, v43
    v_cvt_pk_bf16_f32 v84, v44, v48
    v_cvt_pk_bf16_f32 v88, -v48, v44
    v_cvt_pk_bf16_f32 v85, v45, v49
    v_cvt_pk_bf16_f32 v89, -v49, v45
    buffer_load_dwordx4 v6, s[24:27], s0 offen  lds
    buffer_load_dwordx4 v6, s[24:27], s1 offen offset:1024  lds
    s_mov_b32 s52, 0x78
    s_lshl_b32 s53, s3, 11
    s_lshr_b32 s51, s3, 1
    v_lshl_add_u32 v91, v0, 3, s53
    v_lshrrev_b32 v97, 1, v1
    v_and_b32 v97, 6, v97
    v_bfe_u32 v97, s52, v97, 2
    v_xor_b32 v12, v2, v97
    v_lshlrev_b32 v12, 4, v12
    v_lshl_add_u32 v12, v1, 6, v12
    v_add_u32 v93, s53, v12
    v_cmp_gt_u32 vcc, 2, v2
    v_sub_u32 v13, 16, v1
    v_and_b32 v13, 15, v13
    v_cndmask_b32 v14, v13, v1, vcc
    v_and_b32 v15, 1, v2
    v_lshlrev_b32 v15, 13, v15
    v_lshrrev_b32 v16, 1, v2
    v_lshl_add_u32 v15, v16, 10, v15
    v_lshl_add_u32 v15, v14, 6, v15
    v_lshrrev_b32 v16, 1, v14
    v_and_b32 v16, 6, v16
    v_bfe_u32 v16, s52, v16, 2
    v_xor_b32 v16, s51, v16
    v_lshl_add_u32 v15, v16, 4, v15
    s_and_b32 s50, s3, 1
    s_lshl_b32 s50, s50, 3
    s_add_u32 s49, s50, 40960
    v_add_u32 v92, s49, v15
    v_bfe_u32 v12, v1, 1, 2
    v_xor_b32 v12, v2, v12
    v_lshlrev_b32 v12, 4, v12
    v_lshl_add_u32 v12, v1, 6, v12
    v_add_u32 v94, s53, v12
    v_mov_b32 v98, v4
    v_mov_b32 v99, v5
    s_cmp_lg_u32 s3, 0
    s_cbranch_scc1 A_w0done
    v_sub_u32 v12, 16, v4
    v_cmp_eq_u32 vcc, 0, v4
    s_nop 1
    v_cndmask_b32_e64 v12, v12, 8, vcc
    v_cmp_eq_u32 vcc, 0, v5
    s_nop 1
    v_cndmask_b32 v98, v12, v4, vcc
    v_mov_b32 v99, 0
A_w0done:
    s_movk_i32 s62, 1024
    s_cmp_lg_u32 s3, 0
    s_cselect_b32 s62, 512, s62
    v_bfe_u32 v12, v98, 1, 2
    v_xor_b32 v12, v3, v12
    v_lshlrev_b32 v12, 4, v12
    v_lshl_add_u32 v12, v98, 6, v12
    v_lshl_add_u32 v12, v99, 10, v12
    v_add_u32 v95, s53, v12
    v_add_u32 v96, s62, v95
    v_lshlrev_b32 v12, 3, v3
    s_waitcnt lgkmcnt(0)
    s_add_u32 s22, s22, 1
    s_mul_i32 s60, s22, 0x01010101
    s_xor_b32 s60, s60, 0xcccccccc
    v_lshrrev_b32 v13, v12, s60
    s_mov_b32 s60, 0x10001
    v_bfe_u32 v8, v13, 0, 2
    v_bfe_u32 v9, v13, 2, 2
    v_bfe_u32 v10, v13, 4, 2
    v_bfe_u32 v11, v13, 6, 2
    v_lshl_or_b32 v8, v8, 15, v8
    v_lshl_or_b32 v9, v9, 15, v9
    v_lshl_or_b32 v10, v10, 15, v10
    v_lshl_or_b32 v11, v11, 15, v11
    v_and_b32 v8, s60, v8
    v_and_b32 v9, s60, v9
    v_and_b32 v10, s60, v10
    v_and_b32 v11, s60, v11
    s_and_b32 s56, s23, 15
    s_mov_b32 s57, s56
    s_lshr_b32 s58, s23, 4
    s_lshl_b32 s58, s58, 1
    s_add_u32 s59, s58, 1
    s_cmp_ge_u32 s23, 16
    s_cbranch_scc1 A_halves
    s_and_b32 s56, s23, 7
    s_sub_u32 s57, 16, s56
    s_cmp_eq_u32 s56, 0
    s_cselect_b32 s57, 8, s57
    s_lshr_b32 s58, s23, 3
    s_mov_b32 s59, s58
A_halves:
    s_mov_b32 s28, s6
    s_mov_b32 s29, s7
    s_mov_b32 s30, 0x101000
    s_mov_b32 s31, 0x20000
    s_mov_b32 s32, s8
    s_mov_b32 s33, s9
    s_mov_b32 s34, 0x101000
    s_mov_b32 s35, 0x20000
    s_waitcnt vmcnt(0)
A_xin:
    ds_read_b64_tr_b16 v[122:123], v91 offset:0
    ds_read_b64_tr_b16 v[124:125], v91 offset:512
    ds_read_b64_tr_b16 v[126:127], v91 offset:1024
    ds_read_b64_tr_b16 v[128:129], v91 offset:1536
    s_waitcnt lgkmcnt(2)
    v_mfma_f32_16x16x32_bf16 v[130:133], v[122:125], v[50:53], 0
    v_mfma_f32_16x16x32_bf16 v[138:141], v[122:125], v[54:57], 0
    s_waitcnt lgkmcnt(0)
    v_mfma_f32_16x16x32_bf16 v[134:137], v[126:129], v[50:53], 0
    v_mfma_f32_16x16x32_bf16 v[142:145], v[126:129], v[54:57], 0
    s_nop 3
    v_mul_f32 v146, v130, v58
    v_mul_f32 v154, v138, v58
    v_mul_f32 v147, v131, v59
    v_mul_f32 v155, v139, v59
    v_mul_f32 v148, v132, v60
    v_mul_f32 v156, v140, v60
    v_mul_f32 v149, v133, v61
    v_mul_f32 v157, v141, v61
    v_fma_f32 v146, -v138, v62, v146
    v_fmac_f32 v154, v130, v62
    v_fma_f32 v147, -v139, v63, v147
    v_fmac_f32 v155, v131, v63
    v_fma_f32 v148, -v140, v64, v148
    v_fmac_f32 v156, v132, v64
    v_fma_f32 v149, -v141, v65, v149
    v_fmac_f32 v157, v133, v65
    v_cvt_pk_bf16_f32 v178, v146, v154
    v_cvt_pk_bf16_f32 v179, v147, v155
    v_cvt_pk_bf16_f32 v180, v148, v156
    v_cvt_pk_bf16_f32 v181, v149, v157
    s_nop 1
    v_mfma_f32_16x16x32_bf16 v[130:133], v[66:69], v[178:181], 0
    v_mfma_f32_16x16x32_bf16 v[138:141], v[70:73], v[178:181], 0
    v_mfma_f32_16x16x32_bf16 v[162:165], v[74:77], v[178:181], 0
    v_mfma_f32_16x16x32_bf16 v[170:173], v[78:81], v[178:181], 0
    v_mul_f32 v150, v134, v58
    v_mul_f32 v158, v142, v58
    v_mul_f32 v151, v135, v59
    v_mul_f32 v159, v143, v59
    v_mul_f32 v152, v136, v60
    v_mul_f32 v160, v144, v60
    v_mul_f32 v153, v137, v61
    v_mul_f32 v161, v145, v61
    v_fma_f32 v150, -v142, v62, v150
    v_fmac_f32 v158, v134, v62
    v_fma_f32 v151, -v143, v63, v151
    v_fmac_f32 v159, v135, v63
    v_fma_f32 v152, -v144, v64, v152
    v_fmac_f32 v160, v136, v64
    v_fma_f32 v153, -v145, v65, v153
    v_fmac_f32 v161, v137, v65
    v_cvt_pk_bf16_f32 v182, v150, v158
    v_cvt_pk_bf16_f32 v183, v151, v159
    v_cvt_pk_bf16_f32 v184, v152, v160
    v_cvt_pk_bf16_f32 v185, v153, v161
    s_nop 1
    v_mfma_f32_16x16x32_bf16 v[134:137], v[66:69], v[182:185], 0
    v_mfma_f32_16x16x32_bf16 v[142:145], v[70:73], v[182:185], 0
    v_mfma_f32_16x16x32_bf16 v[166:169], v[74:77], v[182:185], 0
    v_mfma_f32_16x16x32_bf16 v[174:177], v[78:81], v[182:185], 0
    v_cvt_pk_bf16_f32 v186, v130, v138
    v_cvt_pk_bf16_f32 v188, v131, v139
    v_cvt_pk_bf16_f32 v190, v132, v140
    v_cvt_pk_bf16_f32 v192, v133, v141
    s_nop 1
    v_cvt_pk_bf16_f32 v187, v134, v142
    v_cvt_pk_bf16_f32 v189, v135, v143
    v_cvt_pk_bf16_f32 v191, v136, v144
    v_cvt_pk_bf16_f32 v193, v137, v145
    s_mov_b64 exec, s[54:55]
    v_cvt_pk_bf16_f32 v186, v162, v170
    v_cvt_pk_bf16_f32 v188, v163, v171
    v_cvt_pk_bf16_f32 v190, v164, v172
    v_cvt_pk_bf16_f32 v192, v165, v173
    v_cvt_pk_bf16_f32 v187, v166, v174
    v_cvt_pk_bf16_f32 v189, v167, v175
    v_cvt_pk_bf16_f32 v191, v168, v176
    v_cvt_pk_bf16_f32 v193, v169, v177
    s_mov_b64 exec, -1
    ds_write_b64 v92, v[186:187] offset:0
    ds_write_b64 v92, v[188:189] offset:2048
    ds_write_b64 v92, v[190:191] offset:4096
    ds_write_b64 v92, v[192:193] offset:6144
    s_waitcnt lgkmcnt(0)
    s_barrier
    ds_read_b128 v[122:125], v93 offset:40960
    ds_read_b128 v[126:129], v93 offset:41984
    s_lshl_b32 s44, s23, 14
    s_add_u32 s44, s44, s53
    s_add_u32 s44, s44, 65536
    s_waitcnt lgkmcnt(1)
    v_mfma_f32_16x16x32_bf16 v[130:133], v[122:125], v[82:85], 0
    v_mfma_f32_16x16x32_bf16 v[138:141], v[122:125], v[86:89], 0
    s_waitcnt lgkmcnt(0)
    v_mfma_f32_16x16x32_bf16 v[134:137], v[126:129], v[82:85], 0
    v_mfma_f32_16x16x32_bf16 v[142:145], v[126:129], v[86:89], 0
    s_nop 4
    v_cvt_pk_bf16_f32 v178, v130, v138
    v_cvt_pk_bf16_f32 v179, v131, v139
    v_cvt_pk_bf16_f32 v180, v132, v140
    v_cvt_pk_bf16_f32 v181, v133, v141
    ds_write_b128 v94, v[178:181] offset:57344
    v_cvt_pk_bf16_f32 v182, v134, v142
    v_cvt_pk_bf16_f32 v183, v135, v143
    v_cvt_pk_bf16_f32 v184, v136, v144
    v_cvt_pk_bf16_f32 v185, v137, v145
    ds_write_b128 v94, v[182:185] offset:58368
    s_waitcnt lgkmcnt(0)
    ds_read_b128 v[122:125], v95 offset:57344
    ds_read_b128 v[126:129], v96 offset:57344
    s_waitcnt lgkmcnt(1)
    v_bfi_b32 v122, s60, v8, v122
    v_bitop3_b32 v123, s60, v9, v123 bitop3:0x3a
    v_bfi_b32 v124, s60, v10, v124
    v_bitop3_b32 v125, s60, v11, v125 bitop3:0x3a
    buffer_store_dwordx4 v[122:125], v6, s[40:43], s44 offen offset:0 sc1
    s_waitcnt lgkmcnt(0)
    v_bfi_b32 v126, s60, v8, v126
    v_bitop3_b32 v127, s60, v9, v127 bitop3:0x3a
    v_bfi_b32 v128, s60, v10, v128
    v_bitop3_b32 v129, s60, v11, v129 bitop3:0x3a
    buffer_store_dwordx4 v[126:129], v6, s[40:43], s44 offen offset:1024 sc1
    s_cmp_ge_u32 s3, 4
    s_cselect_b32 s46, s57, s56
    s_cselect_b32 s47, s59, s58
    s_and_b32 s48, s3, 1
    s_lshl_b32 s48, s48, 3
    s_bfe_u32 s49, s3, 0x10001
    s_lshl_b32 s45, s49, 6
    s_add_u32 s45, s45, s48
    s_lshl_b32 s45, s45, 4
    s_add_u32 s45, s45, s46
    s_mul_i32 s45, s45, 514
    s_lshl_b32 s47, s47, 5
    s_add_u32 s45, s45, s47
    v_bfe_u32 v12, v0, 1, 2
    v_lshl_add_u32 v13, v12, 4, v4
    v_mul_u32_u24 v13, 8224, v13
    v_and_b32 v14, 1, v0
    v_lshl_add_u32 v13, v14, 4, v13
    buffer_load_dwordx4 v[18:21], v13, s[28:31], s45 offen
    buffer_load_dwordx4 v[22:25], v13, s[32:35], s45 offen
    s_cmp_ge_u32 s23, 8
    s_cbranch_scc1 A_no256
    s_cmp_ge_u32 s3, 4
    s_cselect_b32 s46, s57, s56
    s_and_b32 s47, s3, 1
    s_lshl_b32 s47, s47, 10
    s_add_u32 s47, s47, s46
    s_mul_i32 s47, s47, 514
    s_add_u32 s47, s47, 512
    v_and_b32 v13, 3, v0
    v_lshrrev_b32 v15, 2, v0
    v_lshl_add_u32 v13, v13, 4, v15
    v_mul_u32_u24 v13, 8224, v13
    s_bitcmp1_b32 s3, 1
    s_cbranch_scc1 A_256i
    buffer_load_ushort v26, v13, s[28:31], s47 offen
    s_branch A_no256
A_256i:
    buffer_load_ushort v26, v13, s[32:35], s47 offen
A_no256:
    v_bfe_u32 v12, v0, 1, 2
    v_and_b32 v14, 1, v0
    s_and_b32 s48, s3, 1
    s_lshl_b32 s48, s48, 3
    s_bfe_u32 s49, s3, 0x10001
    v_mul_u32_u24 v14, 8256, v14
    v_lshl_add_u32 v14, v4, 4, v14
    v_lshl_add_u32 v14, v12, 2, v14
    s_lshr_b32 s45, s3, 1
    s_lshl_b32 s45, s45, 8
    s_lshl_b32 s48, s48, 4
    s_add_u32 s45, s45, s48
    s_add_u32 s45, s45, 16384
    v_add_u32 v27, s45, v14
    s_mul_i32 s45, s3, 2064
    s_add_u32 s45, s45, 16384
    v_add_u32 v28, s45, v6
    s_lshl_b32 s49, s49, 10
    s_lshr_b32 s45, s3, 2
    s_lshl_b32 s45, s45, 9
    s_add_u32 s49, s49, s45
    s_and_b32 s45, s3, 1
    s_lshl_b32 s45, s45, 8
    s_add_u32 s49, s49, s45
    v_lshl_add_u32 v29, v0, 2, s49
    v_mul_f32 v46, v38, v35
    v_mul_f32 v47, v39, v35
    v_mul_f32 v48, v40, v35
    v_mul_f32 v49, v41, v35
    v_cos_f32 v42, v46
    v_cos_f32 v43, v47
    v_cos_f32 v44, v48
    v_cos_f32 v45, v49
    v_sin_f32 v46, v46
    v_sin_f32 v47, v47
    v_sin_f32 v48, v48
    v_sin_f32 v49, v49
    v_cvt_pk_bf16_f32 v50, v42, v46
    v_cvt_pk_bf16_f32 v54, -v46, v42
    v_cvt_pk_bf16_f32 v66, v42, -v46
    v_cvt_pk_bf16_f32 v70, v46, v42
    v_cvt_pk_bf16_f32 v51, v43, v47
    v_cvt_pk_bf16_f32 v55, -v47, v43
    v_cvt_pk_bf16_f32 v67, v43, -v47
    v_cvt_pk_bf16_f32 v71, v47, v43
    v_cvt_pk_bf16_f32 v52, v44, v48
    v_cvt_pk_bf16_f32 v56, -v48, v44
    v_cvt_pk_bf16_f32 v68, v44, -v48
    v_cvt_pk_bf16_f32 v72, v48, v44
    v_cvt_pk_bf16_f32 v53, v45, v49
    v_cvt_pk_bf16_f32 v57, -v49, v45
    v_cvt_pk_bf16_f32 v69, v45, -v49
    v_cvt_pk_bf16_f32 v73, v49, v45
    v_and_b32 v13, 7, v1
    v_cvt_f32_u32 v13, v13
    v_mul_f32 v35, 0x3e000000, v13
    v_lshrrev_b32 v14, 3, v1
    v_lshrrev_b32 v15, 1, v2
    v_cmp_eq_u32 vcc, v14, v15
    s_nop 1
    v_cndmask_b32_e64 v14, 0, 1.0, vcc
    v_mul_f32 v46, v38, v35
    v_mul_f32 v47, v39, v35
    v_mul_f32 v48, v40, v35
    v_mul_f32 v49, v41, v35
    v_cos_f32 v42, v46
    v_cos_f32 v43, v47
    v_cos_f32 v44, v48
    v_cos_f32 v45, v49
    v_sin_f32 v46, v46
    v_sin_f32 v47, v47
    v_sin_f32 v48, v48
    v_sin_f32 v49, v49
    v_mul_f32 v42, v42, v14
    v_mul_f32 v46, v46, v14
    v_mul_f32 v43, v43, v14
    v_mul_f32 v47, v47, v14
    v_mul_f32 v44, v44, v14
    v_mul_f32 v48, v48, v14
    v_mul_f32 v45, v45, v14
    v_mul_f32 v49, v49, v14
    v_cvt_pk_bf16_f32 v74, v42, v46
    v_cvt_pk_bf16_f32 v78, -v46, v42
    v_cvt_pk_bf16_f32 v75, v43, v47
    v_cvt_pk_bf16_f32 v79, -v47, v43
    v_cvt_pk_bf16_f32 v76, v44, v48
    v_cvt_pk_bf16_f32 v80, -v48, v44
    v_cvt_pk_bf16_f32 v77, v45, v49
    v_cvt_pk_bf16_f32 v81, -v49, v45
    v_mul_f32 v42, 0x36000000, v42
    v_mul_f32 v46, 0x36000000, v46
    v_mul_f32 v43, 0x36000000, v43
    v_mul_f32 v47, 0x36000000, v47
    v_mul_f32 v44, 0x36000000, v44
    v_mul_f32 v48, 0x36000000, v48
    v_mul_f32 v45, 0x36000000, v45
    v_mul_f32 v49, 0x36000000, v49
    v_cvt_pk_bf16_f32 v82, v42, -v46
    v_cvt_pk_bf16_f32 v86, v46, v42
    v_cvt_pk_bf16_f32 v83, v43, -v47
    v_cvt_pk_bf16_f32 v87, v47, v43
    v_cvt_pk_bf16_f32 v84, v44, -v48
    v_cvt_pk_bf16_f32 v88, v48, v44
    v_cvt_pk_bf16_f32 v85, v45, -v49
    v_cvt_pk_bf16_f32 v89, v49, v45
    s_cmp_lt_u32 s23, 8
    s_cbranch_scc1 A_skt5
    s_lshr_b32 s45, s23, 3
    s_lshl_b32 s45, s45, 3
    s_add_u32 s45, s45, s3
    s_mov_b32 exec_hi, 0
    s_mov_b32 s88, s12
    s_mov_b32 s89, s13
    s_mov_b32 s90, 0x180000
    s_mov_b32 s91, 0x20000
    s_mul_i32 s49, s45, 12288
    v_mul_u32_u24 v252, 3072, v4
    v_and_b32 v251, 7, v0
    v_lshl_add_u32 v252, v251, 7, v252
    buffer_load_dword v253, v252, s[88:91], s49 offen
    s_mov_b64 exec, -1
A_skt5:
    v_and_b32 v13, 7, v1
    v_cvt_f32_u32 v13, v13
    v_mul_f32 v16, 0x3c000000, v13
    v_lshrrev_b32 v15, 1, v2
    v_cvt_f32_u32 v15, v15
    v_mul_f32 v118, v38, v16
    v_mul_f32 v119, v39, v16
    v_mul_f32 v120, v40, v16
    v_mul_f32 v121, v41, v16
    v_cos_f32 v114, v118
    v_cos_f32 v115, v119
    v_cos_f32 v116, v120
    v_cos_f32 v117, v121
    v_sin_f32 v118, v118
    v_sin_f32 v119, v119
    v_sin_f32 v120, v120
    v_sin_f32 v121, v121
    v_mul_f32 v16, 0xbc000000, v34
    v_mul_f32 v17, 0x3d800000, v34
    v_mul_f32 v17, v17, v15
    v_fma_f32 v110, v38, v16, v17
    v_fma_f32 v111, v39, v16, v17
    v_fma_f32 v112, v40, v16, v17
    v_fma_f32 v113, v41, v16, v17
    v_cos_f32 v106, v110
    v_cos_f32 v107, v111
    v_cos_f32 v108, v112
    v_cos_f32 v109, v113
    v_sin_f32 v110, v110
    v_sin_f32 v111, v111
    v_sin_f32 v112, v112
    v_sin_f32 v113, v113
    v_and_b32 v12, 7, v0
    v_lshlrev_b32 v12, 4, v12
    v_lshl_add_u32 v100, v4, 17, v12
    v_lshl_add_u32 v13, v5, 3, s3
    v_lshrrev_b32 v14, 1, v13
    v_and_b32 v14, 6, v14
    v_bfe_u32 v14, s52, v14, 2
    v_xor_b32 v13, v13, v5
    v_lshrrev_b32 v15, 2, v4
    v_xor_b32 v14, v14, v15
    v_xor_b32 v14, v14, v3
    v_and_b32 v15, 3, v4
    v_lshl_add_u32 v15, v14, 2, v15
    v_lshl_add_u32 v15, v13, 4, v15
    v_lshl_add_u32 v15, v3, 10, v15
    v_lshlrev_b32 v101, 2, v15
    v_xor_b32 v102, 32, v101
    v_lshrrev_b32 v13, 3, v1
    v_xor_b32 v14, v1, v13
    v_xor_b32 v15, v2, v97
    v_xor_b32 v15, s51, v15
    v_lshlrev_b32 v15, 4, v15
    v_lshl_add_u32 v15, v14, 6, v15
    v_add_u32 v103, s53, v15
    v_and_b32 v14, 6, v1
    v_xor_b32 v14, s3, v14
    v_lshlrev_b32 v14, 3, v14
    v_lshl_add_u32 v14, v13, 6, v14
    v_and_b32 v13, 7, v1
    v_lshl_add_u32 v14, v13, 7, v14
    v_lshl_add_u32 v104, v2, 12, v14
    v_xor_b32 v13, v3, v2
    v_lshlrev_b32 v13, 4, v13
    v_lshl_add_u32 v13, v5, 6, v13
    v_lshl_add_u32 v13, v4, 7, v13
    v_add_u32 v105, s53, v13
    v_add_u32 v101, 73728, v101
    v_add_u32 v102, 73728, v102
    v_add_u32 v103, 73728, v103
    v_add_u32 v104, 90112, v104
    v_add_u32 v105, 90112, v105
    s_lshl_b32 s46, s3, 14
    s_lshl_b32 s47, s23, 7
    s_add_u32 s46, s46, s47
    s_add_u32 s46, s46, 65536
    s_add_u32 s47, s46, 1048576
    s_waitcnt vmcnt(0)
    s_mov_b32 s61, 100000
    buffer_load_dwordx4 v[122:125], v100, s[40:43], s46 offen sc1
    buffer_load_dwordx4 v[126:129], v100, s[40:43], s47 offen sc1
    s_lshr_b32 s45, s23, 3
    s_lshl_b32 s45, s45, 3
    s_add_u32 s45, s45, s3
    s_mov_b32 exec_hi, 0
    s_mov_b32 s88, s14
    s_mov_b32 s89, s15
    s_mov_b32 s90, 0x80000
    s_mov_b32 s91, 0x20000
    s_lshl_b32 s49, s45, 12
    v_lshlrev_b32 v252, 7, v0
    buffer_load_dword v253, v252, s[88:91], s49 offen
    s_and_b32 s49, s23, 7
    s_lshl_b32 s49, s49, 7
    s_add_u32 s49, s49, s45
    s_lshl_b32 s49, s49, 11
    s_add_u32 s49, s49, 4390912
    v_lshlrev_b32 v252, 7, v0
    s_mov_b64 exec, 0xffff
    buffer_load_dword v253, v252, s[40:43], s49 offen
    s_mov_b64 exec, -1
    ds_write_b32 v27, v18 offset:0
    ds_write_b32 v27, v19 offset:2064
    ds_write_b32 v27, v20 offset:4128
    ds_write_b32 v27, v21 offset:6192
    ds_write_b32 v27, v22 offset:1024
    ds_write_b32 v27, v23 offset:3088
    ds_write_b32 v27, v24 offset:5152
    ds_write_b32 v27, v25 offset:7216
    ds_write_b32 v29, v26 offset:34816
    s_waitcnt lgkmcnt(0)
    s_barrier
    ds_read_b128 v[194:197], v28
    ds_read_b128 v[198:201], v28 offset:1024
    s_waitcnt lgkmcnt(1)
    v_lshlrev_b32 v202, 16, v194
    v_and_b32 v206, 0xffff0000, v194
    v_lshlrev_b32 v203, 16, v195
    v_and_b32 v207, 0xffff0000, v195
    v_lshlrev_b32 v204, 16, v196
    v_and_b32 v208, 0xffff0000, v196
    v_lshlrev_b32 v205, 16, v197
    v_and_b32 v209, 0xffff0000, v197
    s_waitcnt lgkmcnt(0)
    v_lshlrev_b32 v210, 16, v198
    v_and_b32 v214, 0xffff0000, v198
    v_lshlrev_b32 v211, 16, v199
    v_and_b32 v215, 0xffff0000, v199
    v_lshlrev_b32 v212, 16, v200
    v_and_b32 v216, 0xffff0000, v200
    v_lshlrev_b32 v213, 16, v201
    v_and_b32 v217, 0xffff0000, v201
    s_cmp_lt_u32 s23, 8
    s_cselect_b32 s63, s3, 1
    s_cmp_lg_u32 s63, 0
    s_cbranch_scc1 A_nospc1
    ds_read_b128 v[146:149], v6 offset:34816
    ds_read_b128 v[150:153], v6 offset:35840
    v_and_b32 v14, 1, v2
    v_lshl_add_u32 v14, v14, 6, v1
    v_lshrrev_b32 v15, 1, v2
    v_lshl_add_u32 v16, v15, 7, v14
    v_mov_b32 v17, 0xff
    v_mov_b32 v13, 0xff
    s_cmp_lg_u32 s23, 0
    s_cbranch_scc1 A_mir
    v_cmp_gt_u32 vcc, 2, v2
    v_mov_b32 v14, 383
    v_mov_b32 v15, 128
    v_cndmask_b32 v17, v14, v15, vcc
    v_mov_b32 v15, 127
    v_cndmask_b32 v13, v13, v15, vcc
A_mir:
    v_sub_u32 v17, v17, v16
    v_subrev_u32 v14, 0, v17
    v_and_b32 v14, v14, v13
    v_and_b32 v15, 0xc0, v14
    v_and_b32 v16, 15, v14
    v_lshl_add_u32 v15, v16, 2, v15
    v_bfe_u32 v16, v14, 4, 2
    v_add_lshl_u32 v226, v15, v16, 2
    ds_read2st64_b32 v[130:131], v226 offset0:64 offset1:68
    ds_read2st64_b32 v[162:163], v226 offset0:136 offset1:140
    v_subrev_u32 v14, 16, v17
    v_and_b32 v14, v14, v13
    v_and_b32 v15, 0xc0, v14
    v_and_b32 v16, 15, v14
    v_lshl_add_u32 v15, v16, 2, v15
    v_bfe_u32 v16, v14, 4, 2
    v_add_lshl_u32 v227, v15, v16, 2
    ds_read2st64_b32 v[132:133], v227 offset0:64 offset1:68
    ds_read2st64_b32 v[164:165], v227 offset0:136 offset1:140
    v_subrev_u32 v14, 32, v17
    v_and_b32 v14, v14, v13
    v_and_b32 v15, 0xc0, v14
    v_and_b32 v16, 15, v14
    v_lshl_add_u32 v15, v16, 2, v15
    v_bfe_u32 v16, v14, 4, 2
    v_add_lshl_u32 v228, v15, v16, 2
    ds_read2st64_b32 v[134:135], v228 offset0:64 offset1:68
    ds_read2st64_b32 v[166:167], v228 offset0:136 offset1:140
    v_subrev_u32 v14, 48, v17
    v_and_b32 v14, v14, v13
    v_and_b32 v15, 0xc0, v14
    v_and_b32 v16, 15, v14
    v_lshl_add_u32 v15, v16, 2, v15
    v_bfe_u32 v16, v14, 4, 2
    v_add_lshl_u32 v229, v15, v16, 2
    ds_read2st64_b32 v[136:137], v229 offset0:64 offset1:68
    ds_read2st64_b32 v[168:169], v229 offset0:136 offset1:140
    s_waitcnt lgkmcnt(0)
    v_lshlrev_b32 v130, 16, v130
    v_lshlrev_b32 v131, 16, v131
    v_lshlrev_b32 v132, 16, v132
    v_lshlrev_b32 v133, 16, v133
    v_lshlrev_b32 v134, 16, v134
    v_lshlrev_b32 v135, 16, v135
    v_lshlrev_b32 v136, 16, v136
    v_lshlrev_b32 v137, 16, v137
    v_lshlrev_b32 v146, 16, v146
    v_lshlrev_b32 v147, 16, v147
    v_lshlrev_b32 v148, 16, v148
    v_lshlrev_b32 v149, 16, v149
    v_lshlrev_b32 v150, 16, v150
    v_lshlrev_b32 v151, 16, v151
    v_lshlrev_b32 v152, 16, v152
    v_lshlrev_b32 v153, 16, v153
    v_lshlrev_b32 v162, 16, v162
    v_lshlrev_b32 v163, 16, v163
    v_lshlrev_b32 v164, 16, v164
    v_lshlrev_b32 v165, 16, v165
    v_lshlrev_b32 v166, 16, v166
    v_lshlrev_b32 v167, 16, v167
    v_lshlrev_b32 v168, 16, v168
    v_lshlrev_b32 v169, 16, v169
    v_add_f32 v130, v202, v130
    v_sub_f32 v131, v210, v131
    v_add_f32 v146, v146, v162
    v_sub_f32 v150, v150, v163
    v_add_f32 v202, v130, v146
    v_add_f32 v210, v131, v150
    v_sub_f32 v218, v130, v146
    v_sub_f32 v222, v131, v150
    v_mul_f32 v202, 0x3e800000, v202
    v_mul_f32 v210, 0x3e800000, v210
    v_mul_f32 v218, 0x3e800000, v218
    v_mul_f32 v222, 0x3e800000, v222
    v_add_f32 v132, v203, v132
    v_sub_f32 v133, v211, v133
    v_add_f32 v147, v147, v164
    v_sub_f32 v151, v151, v165
    v_add_f32 v203, v132, v147
    v_add_f32 v211, v133, v151
    v_sub_f32 v219, v132, v147
    v_sub_f32 v223, v133, v151
    v_mul_f32 v203, 0x3e800000, v203
    v_mul_f32 v211, 0x3e800000, v211
    v_mul_f32 v219, 0x3e800000, v219
    v_mul_f32 v223, 0x3e800000, v223
    v_add_f32 v134, v204, v134
    v_sub_f32 v135, v212, v135
    v_add_f32 v148, v148, v166
    v_sub_f32 v152, v152, v167
    v_add_f32 v204, v134, v148
    v_add_f32 v212, v135, v152
    v_sub_f32 v220, v134, v148
    v_sub_f32 v224, v135, v152
    v_mul_f32 v204, 0x3e800000, v204
    v_mul_f32 v212, 0x3e800000, v212
    v_mul_f32 v220, 0x3e800000, v220
    v_mul_f32 v224, 0x3e800000, v224
    v_add_f32 v136, v205, v136
    v_sub_f32 v137, v213, v137
    v_add_f32 v149, v149, v168
    v_sub_f32 v153, v153, v169
    v_add_f32 v205, v136, v149
    v_add_f32 v213, v137, v153
    v_sub_f32 v221, v136, v149
    v_sub_f32 v225, v137, v153
    v_mul_f32 v205, 0x3e800000, v205
    v_mul_f32 v213, 0x3e800000, v213
    v_mul_f32 v221, 0x3e800000, v221
    v_mul_f32 v225, 0x3e800000, v225
A_nospc1:
    s_waitcnt vmcnt(2)
    s_branch A_poll1_w
A_poll1:
    s_waitcnt vmcnt(0)
A_poll1_w:
    v_xor_b32 v122, v122, v8
    v_xor_b32 v123, v123, v9
    v_xor_b32 v124, v124, v10
    v_xor_b32 v125, v125, v11
    v_bitop3_b32 v12, v122, v122, v123 bitop3:0xfd
    v_bitop3_b32 v12, v12, v124, v125 bitop3:0xfd
    v_xor_b32 v126, v126, v8
    v_xor_b32 v127, v127, v9
    v_xor_b32 v128, v128, v10
    v_xor_b32 v129, v129, v11
    v_bitop3_b32 v12, v12, v126, v127 bitop3:0xfd
    v_bitop3_b32 v12, v12, v128, v129 bitop3:0xfd
    v_and_b32 v12, s60, v12
    v_cmp_ne_u32 vcc, 0, v12
    s_cbranch_vccz A_poll1_done
    s_sub_u32 s61, s61, 1
    s_cbranch_scc1 A_poll1_done
    buffer_load_dwordx4 v[122:125], v100, s[40:43], s46 offen sc1
    buffer_load_dwordx4 v[126:129], v100, s[40:43], s47 offen sc1
    s_branch A_poll1
A_poll1_done:
    ds_write_b32 v101, v122 offset:0
    ds_write_b32 v101, v123 offset:1024
    ds_write_b32 v101, v124 offset:2048
    ds_write_b32 v101, v125 offset:3072
    ds_write_b32 v102, v126 offset:0
    ds_write_b32 v102, v127 offset:1024
    ds_write_b32 v102, v128 offset:2048
    ds_write_b32 v102, v129 offset:3072
    s_waitcnt lgkmcnt(0)
    s_barrier
    ds_read_b128 v[122:125], v103 offset:0
    ds_read_b128 v[126:129], v103 offset:1024
    s_or_b32 s48, s23, s3
    s_cmp_lg_u32 s48, 0
    s_cbranch_scc1 A_nononce
    v_mov_b32 v12, s22
    v_mov_b32 v13, 0
    buffer_store_dword v12, v13, s[40:43], 0 offen offset:0
A_nononce:
    v_and_b32 v12, 7, v0
    v_lshlrev_b32 v12, 4, v12
    v_lshl_add_u32 v100, v4, 14, v12
    v_xor_b32 v8, 0x10000, v8
    s_lshl_b32 s46, s3, 18
    s_lshl_b32 s47, s23, 7
    s_add_u32 s46, s46, s47
    s_add_u32 s46, s46, 65536
    s_add_u32 s47, s46, 131072
    s_waitcnt lgkmcnt(1)
    v_mfma_f32_16x16x32_bf16 v[130:133], v[122:125], v[50:53], 0
    v_mfma_f32_16x16x32_bf16 v[138:141], v[122:125], v[54:57], 0
    s_waitcnt lgkmcnt(0)
    v_mfma_f32_16x16x32_bf16 v[134:137], v[126:129], v[50:53], 0
    v_mfma_f32_16x16x32_bf16 v[142:145], v[126:129], v[54:57], 0
    s_nop 3
    v_mul_f32 v146, v130, v106
    v_mul_f32 v154, v138, v106
    v_mul_f32 v147, v131, v107
    v_mul_f32 v155, v139, v107
    v_mul_f32 v148, v132, v108
    v_mul_f32 v156, v140, v108
    v_mul_f32 v149, v133, v109
    v_mul_f32 v157, v141, v109
    v_fma_f32 v146, -v138, v110, v146
    v_fmac_f32 v154, v130, v110
    v_fma_f32 v147, -v139, v111, v147
    v_fmac_f32 v155, v131, v111
    v_fma_f32 v148, -v140, v112, v148
    v_fmac_f32 v156, v132, v112
    v_fma_f32 v149, -v141, v113, v149
    v_fmac_f32 v157, v133, v113
    v_cvt_pk_bf16_f32 v178, v146, v154
    v_cvt_pk_bf16_f32 v179, v147, v155
    v_cvt_pk_bf16_f32 v180, v148, v156
    v_cvt_pk_bf16_f32 v181, v149, v157
    s_nop 1
    v_mfma_f32_16x16x32_bf16 v[130:133], v[74:77], v[178:181], 0
    v_mfma_f32_16x16x32_bf16 v[138:141], v[78:81], v[178:181], 0
    v_mul_f32 v150, v134, v106
    v_mul_f32 v158, v142, v106
    v_mul_f32 v151, v135, v107
    v_mul_f32 v159, v143, v107
    v_mul_f32 v152, v136, v108
    v_mul_f32 v160, v144, v108
    v_mul_f32 v153, v137, v109
    v_mul_f32 v161, v145, v109
    v_fma_f32 v150, -v142, v110, v150
    v_fmac_f32 v158, v134, v110
    v_fma_f32 v151, -v143, v111, v151
    v_fmac_f32 v159, v135, v111
    v_fma_f32 v152, -v144, v112, v152
    v_fmac_f32 v160, v136, v112
    v_fma_f32 v153, -v145, v113, v153
    v_fmac_f32 v161, v137, v113
    v_cvt_pk_bf16_f32 v182, v150, v158
    v_cvt_pk_bf16_f32 v183, v151, v159
    v_cvt_pk_bf16_f32 v184, v152, v160
    v_cvt_pk_bf16_f32 v185, v153, v161
    s_nop 1
    v_mfma_f32_16x16x32_bf16 v[134:137], v[74:77], v[182:185], 0
    v_mfma_f32_16x16x32_bf16 v[142:145], v[78:81], v[182:185], 0
    v_mul_f32 v146, v130, v202
    v_mul_f32 v154, v138, v202
    v_mul_f32 v147, v131, v203
    v_mul_f32 v155, v139, v203
    v_mul_f32 v148, v132, v204
    v_mul_f32 v156, v140, v204
    v_mul_f32 v149, v133, v205
    v_mul_f32 v157, v141, v205
    v_fma_f32 v146, -v138, v210, v146
    v_fmac_f32 v154, v130, v210
    v_fma_f32 v147, -v139, v211, v147
    v_fmac_f32 v155, v131, v211
    v_fma_f32 v148, -v140, v212, v148
    v_fmac_f32 v156, v132, v212
    v_fma_f32 v149, -v141, v213, v149
    v_fmac_f32 v157, v133, v213
    s_cmp_lg_u32 s63, 0
    s_cbranch_scc1 A_nospc2
    ds_write_b128 v6, v[130:133] offset:36864
    ds_write_b128 v6, v[138:141] offset:37888
    s_waitcnt lgkmcnt(0)
    ds_read2st64_b32 v[186:187], v226 offset0:144 offset1:148
    ds_read2st64_b32 v[188:189], v227 offset0:144 offset1:148
    ds_read2st64_b32 v[190:191], v228 offset0:144 offset1:148
    ds_read2st64_b32 v[192:193], v229 offset0:144 offset1:148
    s_waitcnt lgkmcnt(0)
    v_fmac_f32 v146, v186, v218
    v_fmac_f32 v154, v186, v222
    v_fmac_f32 v146, v187, v222
    v_fma_f32 v154, -v187, v218, v154
    v_fmac_f32 v147, v188, v219
    v_fmac_f32 v155, v188, v223
    v_fmac_f32 v147, v189, v223
    v_fma_f32 v155, -v189, v219, v155
    v_fmac_f32 v148, v190, v220
    v_fmac_f32 v156, v190, v224
    v_fmac_f32 v148, v191, v224
    v_fma_f32 v156, -v191, v220, v156
    v_fmac_f32 v149, v192, v221
    v_fmac_f32 v157, v192, v225
    v_fmac_f32 v149, v193, v225
    v_fma_f32 v157, -v193, v221, v157
A_nospc2:
    v_cvt_pk_bf16_f32 v178, v146, v154
    v_cvt_pk_bf16_f32 v179, v147, v155
    v_cvt_pk_bf16_f32 v180, v148, v156
    v_cvt_pk_bf16_f32 v181, v149, v157
    s_nop 1
    v_mfma_f32_16x16x32_bf16 v[130:133], v[178:181], v[82:85], 0
    v_mfma_f32_16x16x32_bf16 v[138:141], v[178:181], v[86:89], 0
    v_mul_f32 v150, v134, v206
    v_mul_f32 v158, v142, v206
    v_mul_f32 v151, v135, v207
    v_mul_f32 v159, v143, v207
    v_mul_f32 v152, v136, v208
    v_mul_f32 v160, v144, v208
    v_mul_f32 v153, v137, v209
    v_mul_f32 v161, v145, v209
    v_fma_f32 v150, -v142, v214, v150
    v_fmac_f32 v158, v134, v214
    v_fma_f32 v151, -v143, v215, v151
    v_fmac_f32 v159, v135, v215
    v_fma_f32 v152, -v144, v216, v152
    v_fmac_f32 v160, v136, v216
    v_fma_f32 v153, -v145, v217, v153
    v_fmac_f32 v161, v137, v217
    v_cvt_pk_bf16_f32 v182, v150, v158
    v_cvt_pk_bf16_f32 v183, v151, v159
    v_cvt_pk_bf16_f32 v184, v152, v160
    v_cvt_pk_bf16_f32 v185, v153, v161
    s_nop 1
    v_mfma_f32_16x16x32_bf16 v[134:137], v[182:185], v[82:85], 0
    v_mfma_f32_16x16x32_bf16 v[142:145], v[182:185], v[86:89], 0
    v_mul_f32 v146, v130, v114
    v_mul_f32 v154, v138, v114
    v_mul_f32 v147, v131, v115
    v_mul_f32 v155, v139, v115
    v_mul_f32 v148, v132, v116
    v_mul_f32 v156, v140, v116
    v_mul_f32 v149, v133, v117
    v_mul_f32 v157, v141, v117
    v_fma_f32 v146, -v138, v118, v146
    v_fmac_f32 v154, v130, v118
    v_fma_f32 v147, -v139, v119, v147
    v_fmac_f32 v155, v131, v119
    v_fma_f32 v148, -v140, v120, v148
    v_fmac_f32 v156, v132, v120
    v_fma_f32 v149, -v141, v121, v149
    v_fmac_f32 v157, v133, v121
    v_cvt_pk_bf16_f32 v178, v146, v154
    v_cvt_pk_bf16_f32 v179, v147, v155
    v_cvt_pk_bf16_f32 v180, v148, v156
    v_cvt_pk_bf16_f32 v181, v149, v157
    s_nop 1
    v_mfma_f32_16x16x32_bf16 v[130:133], v[66:69], v[178:181], 0
    v_mfma_f32_16x16x32_bf16 v[138:141], v[70:73], v[178:181], 0
    v_mul_f32 v150, v134, v114
    v_mul_f32 v158, v142, v114
    v_mul_f32 v151, v135, v115
    v_mul_f32 v159, v143, v115
    v_mul_f32 v152, v136, v116
    v_mul_f32 v160, v144, v116
    v_mul_f32 v153, v137, v117
    v_mul_f32 v161, v145, v117
    v_fma_f32 v150, -v142, v118, v150
    v_fmac_f32 v158, v134, v118
    v_fma_f32 v151, -v143, v119, v151
    v_fmac_f32 v159, v135, v119
    v_fma_f32 v152, -v144, v120, v152
    v_fmac_f32 v160, v136, v120
    v_fma_f32 v153, -v145, v121, v153
    v_fmac_f32 v161, v137, v121
    v_cvt_pk_bf16_f32 v182, v150, v158
    v_cvt_pk_bf16_f32 v183, v151, v159
    v_cvt_pk_bf16_f32 v184, v152, v160
    v_cvt_pk_bf16_f32 v185, v153, v161
    s_nop 1
    v_mfma_f32_16x16x32_bf16 v[134:137], v[66:69], v[182:185], 0
    v_mfma_f32_16x16x32_bf16 v[142:145], v[70:73], v[182:185], 0
    v_cvt_pk_bf16_f32 v186, v130, v138
    v_cvt_pk_bf16_f32 v188, v131, v139
    v_cvt_pk_bf16_f32 v190, v132, v140
    v_cvt_pk_bf16_f32 v192, v133, v141
    s_nop 3
    v_cvt_pk_bf16_f32 v187, v134, v142
    v_cvt_pk_bf16_f32 v189, v135, v143
    v_cvt_pk_bf16_f32 v191, v136, v144
    v_cvt_pk_bf16_f32 v193, v137, v145
    ds_write_b64 v104, v[186:187] offset:0
    ds_write_b64 v104, v[188:189] offset:1024
    ds_write_b64 v104, v[190:191] offset:2048
    ds_write_b64 v104, v[192:193] offset:3072
    s_waitcnt lgkmcnt(0)
    s_barrier
    ds_read_b128 v[122:125], v105 offset:0
    ds_read_b128 v[126:129], v105 offset:1024
    s_waitcnt lgkmcnt(1)
    v_bitop3_b32 v122, s60, v8, v122 bitop3:0x3a
    v_bfi_b32 v123, s60, v9, v123
    v_bitop3_b32 v124, s60, v10, v124 bitop3:0x3a
    v_bfi_b32 v125, s60, v11, v125
    buffer_store_dwordx4 v[122:125], v100, s[40:43], s46 offen sc1
    s_waitcnt lgkmcnt(0)
    v_bitop3_b32 v126, s60, v8, v126 bitop3:0x3a
    v_bfi_b32 v127, s60, v9, v127
    v_bitop3_b32 v128, s60, v10, v128 bitop3:0x3a
    v_bfi_b32 v129, s60, v11, v129
    buffer_store_dwordx4 v[126:129], v100, s[40:43], s47 offen sc1
    v_cvt_f32_u32 v106, v2
    v_add_f32 v107, 4.0, v106
    v_add_f32 v108, 4.0, v107
    v_add_f32 v109, 4.0, v108
    v_mul_f32 v35, 0x3d800000, v34
    v_add_f32 v36, v35, v90
    v_mul_f32 v46, v106, v36
    v_mul_f32 v47, v107, v36
    v_mul_f32 v48, v108, v36
    v_mul_f32 v49, v109, v36
    v_cos_f32 v42, v46
    v_cos_f32 v43, v47
    v_cos_f32 v44, v48
    v_cos_f32 v45, v49
    v_sin_f32 v46, v46
    v_sin_f32 v47, v47
    v_sin_f32 v48, v48
    v_sin_f32 v49, v49
    v_cvt_pk_bf16_f32 v50, v42, -v46
    v_cvt_pk_bf16_f32 v54, v46, v42
    v_cvt_pk_bf16_f32 v51, v43, -v47
    v_cvt_pk_bf16_f32 v55, v47, v43
    v_cvt_pk_bf16_f32 v52, v44, -v48
    v_cvt_pk_bf16_f32 v56, v48, v44
    v_cvt_pk_bf16_f32 v53, v45, -v49
    v_cvt_pk_bf16_f32 v57, v49, v45
    v_add_f32 v106, v106, v106
    v_add_f32 v107, 1.0, v106
    v_add_f32 v108, 1.0, v106
    v_add_f32 v109, 2.0, v106
    v_mul_f32 v46, v106, v35
    v_mul_f32 v47, v107, v35
    v_mul_f32 v48, v108, v35
    v_mul_f32 v49, v109, v35
    v_cos_f32 v42, v46
    v_cos_f32 v43, v47
    v_cos_f32 v44, v48
    v_cos_f32 v45, v49
    v_sin_f32 v46, v46
    v_sin_f32 v47, v47
    v_sin_f32 v48, v48
    v_sin_f32 v49, v49
    v_cvt_pk_bf16_f32 v66, v42, -v46
    v_cvt_pk_bf16_f32 v70, v46, v42
    v_cvt_pk_bf16_f32 v67, v43, -v47
    v_cvt_pk_bf16_f32 v71, -v47, -v43
    v_cvt_pk_bf16_f32 v68, v44, -v48
    v_cvt_pk_bf16_f32 v72, v48, v44
    v_cvt_pk_bf16_f32 v69, v45, -v49
    v_cvt_pk_bf16_f32 v73, -v49, -v45
    v_mul_f32 v35, 0x3d000000, v34
    v_mul_f32 v46, v38, v35
    v_mul_f32 v47, v39, v35
    v_mul_f32 v48, v40, v35
    v_mul_f32 v49, v41, v35
    v_cos_f32 v42, v46
    v_cos_f32 v43, v47
    v_cos_f32 v44, v48
    v_cos_f32 v45, v49
    v_sin_f32 v46, v46
    v_sin_f32 v47, v47
    v_sin_f32 v48, v48
    v_sin_f32 v49, v49
    v_cvt_pk_bf16_f32 v82, v42, -v46
    v_cvt_pk_bf16_f32 v83, v43, -v47
    v_cvt_pk_bf16_f32 v84, v44, -v48
    v_cvt_pk_bf16_f32 v85, v45, -v49
    v_mov_b32 v74, v66
    v_mov_b32 v75, 0
    v_mov_b32 v76, v68
    v_mov_b32 v77, 0
    v_mov_b32 v78, 0
    v_mov_b32 v79, v83
    v_mov_b32 v80, 0
    v_mov_b32 v81, v85
    v_and_b32 v12, 1, v1
    v_lshlrev_b32 v12, 31, v12
    s_mov_b64 exec, 0xffff
    v_or_b32 v74, 0x3f003f00, v12
    v_or_b32 v82, 0x3f803f80, v12
    s_mov_b64 exec, -1
    v_mov_b32 v86, v82
    v_xor_b32 v87, 0x80008000, v83
    v_mov_b32 v88, v84
    v_xor_b32 v89, 0x80008000, v85
    v_mov_b32 v100, v6
    s_mov_b32 s46, s44
    s_add_u32 s47, s44, 1024
    s_mul_i32 s48, s3, 2176
    s_add_u32 s48, s48, 106496
    s_movk_i32 s62, 1088
    s_cmp_lg_u32 s3, 0
    s_cselect_b32 s62, 512, s62
    v_mul_u32_u24 v12, 1088, v99
    v_lshl_add_u32 v12, v98, 6, v12
    v_lshl_add_u32 v12, v3, 4, v12
    v_add_u32 v91, s48, v12
    v_add_u32 v92, s62, v91
    v_lshl_add_u32 v12, v2, 6, s48
    v_lshl_add_u32 v94, v1, 2, v12
    v_sub_u32 v13, 16, v1
    v_and_b32 v13, 15, v13
    v_lshl_add_u32 v13, v13, 2, v12
    v_add_u32 v95, 1088, v13
    v_xor_b32 v12, s51, v97
    v_lshlrev_b32 v12, 4, v12
    v_lshl_add_u32 v12, v1, 6, v12
    v_lshl_add_u32 v12, v2, 12, v12
    s_add_u32 s49, s50, 126976
    v_add_u32 v96, s49, v12
    v_add_u32 v101, 126976, v93
    v_and_b32 v12, 1, v2
    v_lshlrev_b32 v12, 9, v12
    v_lshl_add_u32 v12, v1, 5, v12
    v_lshrrev_b32 v13, 1, v2
    v_lshl_add_u32 v102, v13, 4, v12
    s_lshl_b32 s44, s3, 8
    s_add_u32 s44, s44, s23
    s_lshl_b32 s44, s44, 11
    s_add_u32 s45, s44, 262144
    v_bfe_u32 v13, v1, 2, 1
    v_lshlrev_b32 v13, 1, v13
    v_xor_b32 v13, v13, v2
    v_lshlrev_b32 v12, 5, v1
    v_lshl_add_u32 v12, v13, 3, v12
    v_add_u32 v102, s53, v12
    v_bfe_u32 v13, v0, 3, 1
    v_lshlrev_b32 v13, 4, v13
    v_xor_b32 v13, v13, v6
    v_add_u32 v104, s53, v13
    s_waitcnt vmcnt(0)
    s_mov_b32 s61, 100000
    buffer_load_dwordx4 v[122:125], v100, s[40:43], s46 offen sc1
    buffer_load_dwordx4 v[126:129], v100, s[40:43], s47 offen sc1
A_poll2:
    s_waitcnt vmcnt(0)
A_poll2_w:
    v_xor_b32 v122, v122, v8
    v_xor_b32 v123, v123, v9
    v_xor_b32 v124, v124, v10
    v_xor_b32 v125, v125, v11
    v_bitop3_b32 v12, v123, v123, v122 bitop3:0xfd
    v_bitop3_b32 v12, v12, v125, v124 bitop3:0xfd
    v_xor_b32 v126, v126, v8
    v_xor_b32 v127, v127, v9
    v_xor_b32 v128, v128, v10
    v_xor_b32 v129, v129, v11
    v_bitop3_b32 v12, v12, v127, v126 bitop3:0xfd
    v_bitop3_b32 v12, v12, v129, v128 bitop3:0xfd
    v_and_b32 v12, s60, v12
    v_cmp_ne_u32 vcc, 0, v12
    s_cbranch_vccz A_poll2_done
    s_sub_u32 s61, s61, 1
    s_cbranch_scc1 A_poll2_done
    buffer_load_dwordx4 v[122:125], v100, s[40:43], s46 offen sc1
    buffer_load_dwordx4 v[126:129], v100, s[40:43], s47 offen sc1
    s_branch A_poll2
A_poll2_done:
    ds_write_b128 v91, v[122:125]
    ds_write_b128 v92, v[126:129]
    s_waitcnt lgkmcnt(0)
    ds_read2_b32 v[122:123], v94 offset0:0 offset1:64
    ds_read2_b32 v[124:125], v94 offset0:128 offset1:192
    ds_read2_b32 v[126:127], v95 offset0:0 offset1:64
    ds_read2_b32 v[128:129], v95 offset0:128 offset1:192
    s_waitcnt lgkmcnt(2)
    v_mfma_f32_16x16x32_bf16 v[130:133], v[50:53], v[122:125], 0
    v_mfma_f32_16x16x32_bf16 v[138:141], v[54:57], v[122:125], 0
    s_waitcnt lgkmcnt(0)
    v_mfma_f32_16x16x32_bf16 v[134:137], v[50:53], v[126:129], 0
    v_mfma_f32_16x16x32_bf16 v[142:145], v[54:57], v[126:129], 0
    s_nop 4
    v_cvt_pk_bf16_f32 v186, v130, v138
    v_cvt_pk_bf16_f32 v188, v131, v139
    v_cvt_pk_bf16_f32 v190, v132, v140
    v_cvt_pk_bf16_f32 v192, v133, v141
    v_cvt_pk_bf16_f32 v187, v134, v142
    v_cvt_pk_bf16_f32 v189, v135, v143
    v_cvt_pk_bf16_f32 v191, v136, v144
    v_cvt_pk_bf16_f32 v193, v137, v145
    ds_write_b64 v96, v[186:187] offset:0
    ds_write_b64 v96, v[188:189] offset:1024
    ds_write_b64 v96, v[190:191] offset:2048
    ds_write_b64 v96, v[192:193] offset:3072
    s_waitcnt lgkmcnt(0)
    s_barrier
    ds_read_b128 v[122:125], v101 offset:0
    ds_read_b128 v[126:129], v101 offset:1024
    s_waitcnt lgkmcnt(1)
    v_mfma_f32_16x16x32_bf16 v[162:165], v[122:125], v[74:77], 0
    v_mfma_f32_16x16x32_bf16 v[170:173], v[122:125], v[78:81], 0
    v_mfma_f32_16x16x32_bf16 v[130:133], v[122:125], v[66:69], 0
    v_mfma_f32_16x16x32_bf16 v[138:141], v[122:125], v[70:73], 0
    s_waitcnt lgkmcnt(0)
    v_mfma_f32_16x16x32_bf16 v[166:169], v[126:129], v[74:77], 0
    v_mfma_f32_16x16x32_bf16 v[174:177], v[126:129], v[78:81], 0
    v_mfma_f32_16x16x32_bf16 v[134:137], v[126:129], v[66:69], 0
    v_mfma_f32_16x16x32_bf16 v[142:145], v[126:129], v[70:73], 0
    s_mov_b64 exec, 0xffff
    s_nop 0
    v_mov_b32 v130, v162
    v_mov_b32 v138, v170
    s_mov_b64 exec, -1
    v_mul_f32 v146, v130, v58
    v_mul_f32 v154, v138, v58
    v_mul_f32 v147, v131, v59
    v_mul_f32 v155, v139, v59
    v_mul_f32 v148, v132, v60
    v_mul_f32 v156, v140, v60
    v_mul_f32 v149, v133, v61
    v_mul_f32 v157, v141, v61
    v_fmac_f32 v146, v138, v62
    v_fma_f32 v154, -v130, v62, v154
    v_fmac_f32 v147, v139, v63
    v_fma_f32 v155, -v131, v63, v155
    v_fmac_f32 v148, v140, v64
    v_fma_f32 v156, -v132, v64, v156
    v_fmac_f32 v149, v141, v65
    v_fma_f32 v157, -v133, v65, v157
    v_cvt_pk_bf16_f32 v178, v146, v154
    v_cvt_pk_bf16_f32 v179, v147, v155
    v_cvt_pk_bf16_f32 v180, v148, v156
    v_cvt_pk_bf16_f32 v181, v149, v157
    s_nop 1
    v_mfma_f32_16x16x32_bf16 v[130:133], v[178:181], v[82:85], 0
    v_mfma_f32_16x16x32_bf16 v[138:141], v[178:181], v[86:89], 0
    s_mov_b64 exec, 0xffff
    v_mov_b32 v134, v166
    v_mov_b32 v142, v174
    s_mov_b64 exec, -1
    v_mul_f32 v150, v134, v58
    v_mul_f32 v158, v142, v58
    v_mul_f32 v151, v135, v59
    v_mul_f32 v159, v143, v59
    v_mul_f32 v152, v136, v60
    v_mul_f32 v160, v144, v60
    v_mul_f32 v153, v137, v61
    v_mul_f32 v161, v145, v61
    v_fmac_f32 v150, v142, v62
    v_fma_f32 v158, -v134, v62, v158
    v_fmac_f32 v151, v143, v63
    v_fma_f32 v159, -v135, v63, v159
    v_fmac_f32 v152, v144, v64
    v_fma_f32 v160, -v136, v64, v160
    v_fmac_f32 v153, v145, v65
    v_fma_f32 v161, -v137, v65, v161
    v_cvt_pk_bf16_f32 v182, v150, v158
    v_cvt_pk_bf16_f32 v183, v151, v159
    v_cvt_pk_bf16_f32 v184, v152, v160
    v_cvt_pk_bf16_f32 v185, v153, v161
    s_nop 1
    v_mfma_f32_16x16x32_bf16 v[134:137], v[182:185], v[82:85], 0
    v_mfma_f32_16x16x32_bf16 v[142:145], v[182:185], v[86:89], 0
    v_cvt_pk_bf16_f32 v122, v130, v131
    v_cvt_pk_bf16_f32 v123, v132, v133
    v_cvt_pk_bf16_f32 v124, v138, v139
    v_cvt_pk_bf16_f32 v125, v140, v141
    ds_write_b64 v102, v[122:123] offset:0
    ds_write_b64 v102, v[124:125] offset:512
    s_nop 0
    v_cvt_pk_bf16_f32 v126, v134, v135
    v_cvt_pk_bf16_f32 v127, v136, v137
    v_cvt_pk_bf16_f32 v128, v142, v143
    v_cvt_pk_bf16_f32 v129, v144, v145
    ds_write_b64 v102, v[126:127] offset:1024
    ds_write_b64 v102, v[128:129] offset:1536
    s_waitcnt lgkmcnt(0)
    ds_read_b128 v[122:125], v104 offset:0
    ds_read_b128 v[126:129], v104 offset:1024
    s_waitcnt lgkmcnt(1)
    buffer_store_dwordx4 v[122:125], v6, s[36:39], s44 offen sc1
    s_waitcnt lgkmcnt(0)
    buffer_store_dwordx4 v[126:129], v6, s[36:39], s45 offen sc1
    s_endpgm
L_end:
    s_endpgm
L_code_end:
.section .rodata,"a"
.p2align 6
.amdhsa_kernel concat_heads__spectral_gfnet__linear_attn_block__prompt_kernel
  .amdhsa_next_free_vgpr 256
  .amdhsa_next_free_sgpr 102
  .amdhsa_accum_offset 256
  .amdhsa_group_segment_fixed_size 0
  .amdhsa_kernarg_size 72
  .amdhsa_user_sgpr_count 2
  .amdhsa_user_sgpr_kernarg_segment_ptr 1
  .amdhsa_system_sgpr_workgroup_id_x 1
.end_amdhsa_kernel
```
